```python
import torch

def _softmax(x, axis=-1):
    return torch.softmax(x, dim=axis)
def _gelu(x):
    return torch.nn.functional.gelu(x, approximate="tanh")
def _silu(x):
    return torch.nn.functional.silu(x)
def _sigmoid(x):
    return torch.sigmoid(x)
def _layernorm(x, axis=-1, eps=1e-5):
    m = x.mean(dim=axis, keepdim=True)
    v = x.var(dim=axis, keepdim=True, unbiased=False)
    return (x - m) / torch.sqrt(v + eps)
def _scatter_add(tgt, idx, src, axis=0):
    return tgt.clone().index_add_(axis, idx, src)
def _segment_sum(src, seg, n):
    out = torch.zeros((n,) + src.shape[1:], dtype=src.dtype)
    return out.index_add_(0, seg, src)
def _pad(x, pw):
    flat = tuple(v for pair in reversed(pw) for v in pair)
    return torch.nn.functional.pad(x, flat)

kernel_name = 'parallel_sum__sliding_local_dilated__moe_arch_mod__prompt'

def setup_inputs():

    _w = (lambda a: (lambda t: t.to(torch.bfloat16) if t.is_floating_point() else t)(torch.as_tensor(a)))
    def _A_setup():
        B, S, D = 1, 2048, 640
        return {
            "x": _w((lambda *s: torch.randn(*s, dtype=torch.bfloat16) * 0.05)(B, S, D)),
            "wqkv": _w((lambda *s: torch.randn(*s, dtype=torch.bfloat16) * 0.05)(D, 3 * D)),
            "wo": _w((lambda *s: torch.randn(*s, dtype=torch.bfloat16) * 0.05)(D, D)),
        }
    _A_in = _A_setup()

    def _B_setup():
        B, S, D, F, C = 1, 2048, 640, 1728, 2
        return {
            "x": _w((lambda *s: torch.randn(*s, dtype=torch.bfloat16) * 0.05)(B, S, D)),
            "w_r": _w((lambda *s: torch.randn(*s, dtype=torch.bfloat16) * 0.05)(D)),
            "w_gate": _w((lambda *s: torch.randn(*s, dtype=torch.bfloat16) * 0.05)(D, F)),
            "w_up": _w((lambda *s: torch.randn(*s, dtype=torch.bfloat16) * 0.05)(D, F)),
            "w_down": _w((lambda *s: torch.randn(*s, dtype=torch.bfloat16) * 0.05)(F, D)),
        }
    _B_in = _B_setup()

    return {
        "A_x": _A_in["x"],
        "A_wqkv": _A_in["wqkv"],
        "A_wo": _A_in["wo"],
        "B_x": _B_in["x"],
        "B_w_r": _B_in["w_r"],
        "B_w_gate": _B_in["w_gate"],
        "B_w_up": _B_in["w_up"],
        "B_w_down": _B_in["w_down"],
    }

def reference(A_x, A_wqkv, A_wo, B_x, B_w_r, B_w_gate, B_w_up, B_w_down):
    def _A_ref(x, wqkv, wo):
        B, S, D = x.shape
        H = 32; Dh = D // H
        W, dil = 8, 2
        qkv = (lambda x, *d: x.permute(*d))((x @ wqkv).reshape(B, S, 3, H, Dh), 2, 0, 3, 1, 4)
        q, k, v = qkv[0], qkv[1], qkv[2]
        scale = Dh ** -0.5
        pos = torch.arange(S)
        off = torch.arange(W) * dil
        idx = pos[:, None] - off[None, :]
        mask = idx >= 0
        idx_c = torch.where(mask, idx, 0).reshape(-1)
        kg = k[:, :, idx_c, :].reshape(B, H, S, W, Dh)
        vg = v[:, :, idx_c, :].reshape(B, H, S, W, Dh)
        logits = torch.einsum("bhsd,bhswd->bhsw", q, kg) * scale
        logits = torch.where(mask[None, None, :, :], logits, -1e9)
        attn = _softmax(logits, axis=-1)
        o = torch.einsum("bhsw,bhswd->bhsd", attn, vg)
        return (lambda x, *d: x.permute(*d))(o, 0, 2, 1, 3).reshape(B, S, D) @ wo

    def _B_ref(x, w_r, w_gate, w_up, w_down):
        B, S, D = x.shape
        C = 2
        r = x @ w_r
        idx = torch.argsort(-r, axis=-1)[:, :C]
        idx_e = (lambda x, n, axis: torch.repeat_interleave(x, n, dim=axis))(idx.reshape(B, C, 1), D, axis=2)
        x_sel = (lambda x, i, axis: torch.take_along_dim(x, i, dim=axis))(x, idx_e, axis=1)
        g = _silu(x_sel @ w_gate)
        u = x_sel @ w_up
        y = (g * u) @ w_down
        r_sel = _sigmoid((lambda x, i, axis: torch.take_along_dim(x, i, dim=axis))(r, idx, axis=1))
        y = y * r_sel.reshape(B, C, 1)
        b_off = (torch.arange(B) * S).reshape(B, 1)
        flat_idx = (idx + b_off).reshape(B * C)
        zero = (x * 0.0).reshape(B * S, D)
        upd = _scatter_add(zero, flat_idx, y.reshape(B * C, D), axis=0)
        return x + upd.reshape(B, S, D)

    x = A_x
    xn = _layernorm(x, axis=-1)
    return x + _A_ref(xn, A_wqkv, A_wo) + _B_ref(xn, B_w_r, B_w_gate, B_w_up, B_w_down)
```

```asm
; @launch grid=(256,1,1) block=(512,1,1) lds=163840
.amdgcn_target "amdgcn-amd-amdhsa--gfx950"
.text
.globl parallel_sum__sliding_local_dilated__moe_arch_mod__prompt_kernel
.p2align 8
.type parallel_sum__sliding_local_dilated__moe_arch_mod__prompt_kernel,@function
parallel_sum__sliding_local_dilated__moe_arch_mod__prompt_kernel:
L_start:
    s_load_dwordx16 s[4:19], s[0:1], 0
    s_xor_b32 s2, s2, 4
    s_and_b32 s27, s2, 7
    s_lshr_b32 s28, s2, 3
    v_readfirstlane_b32 s26, v0
    s_mul_i32 s56, s28, 26
    s_lshr_b32 s56, s56, 8
    s_cmp_eq_u32 s27, 7
    s_cbranch_scc1 L_other
    s_cmp_ge_u32 s28, 30
    s_cbranch_scc1 L_other
    s_mul_i32 s30, s56, 10
    s_sub_u32 s30, s28, s30
    s_getpc_b64 s[58:59]
    v_lshrrev_b32 v1, 5, v0
    v_lshl_add_u32 v1, s30, 4, v1
    v_lshlrev_b32 v1, 7, v1
    global_load_dword v255, v1, s[58:59]
    s_mul_i32 s29, s27, 3
    s_add_u32 s29, s29, s56
    s_sub_u32 s29, 20, s29
    s_mul_i32 s31, s27, 11
    s_lshr_b32 s31, s31, 3
    s_add_u32 s31, s31, s30
    s_sub_u32 s57, s31, 10
    s_min_u32 s31, s31, s57
    s_movk_i32 s60, 1280
    v_lshrrev_b32 v24, 3, v0
    v_lshrrev_b32 v26, 4, v0
    v_xor_b32 v27, v26, v0
    v_and_b32 v27, 7, v27
    v_mul_u32_u24 v23, s60, v24
    v_lshl_add_u32 v46, v27, 4, v23
    s_mul_i32 s57, s29, 124160
    s_lshl_b32 s58, s31, 7
    s_add_u32 s58, s58, s57
    s_mov_b32 s34, 2622720
    s_lshl_b32 s35, 1, 17
    s_lshl_b32 m0, s26, 4
    s_addk_i32 m0, 24576
    s_cmp_eq_u32 s26, 0
    s_cselect_b32 exec_lo, 0xffffff00, -1
    s_waitcnt lgkmcnt(0)
    s_sub_u32 s32, s4, s60
    s_subb_u32 s33, s5, 0
    buffer_load_dwordx4 v46, s[32:35], s58 offen lds
    s_mov_b32 exec_lo, -1
    s_addk_i32 m0, 8192
    s_add_u32 s58, s58, 81920
    s_cmpk_ge_u32 s26, 384
    s_cbranch_scc1 L_x1
    buffer_load_dwordx4 v46, s[32:35], s58 offen lds
L_x1:
    v_and_b32 v25, 2, v24
    v_and_b32 v26, 4, v26
    v_or_b32 v25, v25, v26
    v_xor_b32 v25, v25, v0
    v_and_b32 v25, 7, v25
    v_mul_u32_u24 v23, 3, v23
    v_lshl_add_u32 v47, v25, 4, v23
    s_lshl_b32 s58, s30, 7
    v_add_u32 v47, s58, v47
    s_mul_i32 s59, s31, 245760
    s_mov_b64 s[36:37], s[6:7]
    s_mov_b32 s38, 2457600
    s_lshl_b32 m0, s26, 4
    s_mov_b32 s39, 0x00020000
    s_load_dwordx4 s[20:23], s[0:1], 64
    s_load_dwordx2 s[24:25], s[0:1], 80
    buffer_load_dwordx4 v47, s[36:39], s59 offen lds
    s_addk_i32 m0, 6912
    s_mov_b32 s3, 0
    buffer_load_dwordx4 v47, s[36:39], s59 offen offset:1280 lds
    s_addk_i32 m0, 6912
    s_cmpk_ge_u32 s26, 384
    buffer_load_dwordx4 v47, s[36:39], s59 offen offset:2560 lds
    s_cbranch_scc0 L_w2
    s_mov_b32 s3, 1
L_w1:
    s_setprio 3
L_w2:
    s_lshr_b32 s26, s26, 6
    v_and_b32 v0, 63, v0
    s_sub_u32 s76, s31, 1
    s_min_u32 s76, s76, 9
    s_xor_b32 s28, s26, 4
    s_cmp_lt_u32 s28, 2
    s_cbranch_scc1 L_aux_pre
L_const:
    s_cmp_ge_u32 s30, 5
    s_cselect_b32 s77, 5, 0
    s_sub_u32 s77, s30, s77
    s_lshl_b32 s79, s28, 11
    s_add_u32 s16, s79, 116736
    v_and_b32 v1, 15, v0
    v_lshrrev_b32 v2, 4, v0
    v_lshrrev_b32 v22, 1, v1
    v_lshlrev_b32 v23, 7, v1
    v_xor_b32 v24, v2, v22
    v_lshl_add_u32 v24, v24, 4, v23
    v_add_u32 v198, s16, v24
    v_xor_b32 v199, 64, v198
    v_lshlrev_b32 v3, 4, v0
    s_cmp_eq_u32 s3, 2
    s_cbranch_scc1 L_aux
L_constB:
    v_lshrrev_b32 v24, 1, v2
    v_xor_b32 v24, v24, v22
    v_lshl_add_u32 v24, v24, 4, v23
    v_and_b32 v25, 1, v2
    v_lshl_add_u32 v24, v25, 3, v24
    v_add_u32 v8, s79, v24
    v_lshrrev_b32 v24, 2, v0
    v_and_b32 v25, 3, v0
    v_bfe_u32 v26, v24, 1, 2
    v_lshlrev_b32 v26, 5, v26
    v_lshl_add_u32 v26, v24, 7, v26
    v_lshl_add_u32 v27, v25, 3, v26
    v_add_u32 v4, 38912, v3
    v_add_u32 v5, 96256, v3
    v_lshrrev_b32 v28, 3, v24
    v_lshlrev_b32 v28, 4, v28
    v_xor_b32 v27, v27, v28
    v_and_b32 v28, 1, v24
    v_lshlrev_b32 v28, 3, v28
    v_xor_b32 v27, v27, v28
    v_add_u32 v200, s16, v27
    v_xor_b32 v201, 32, v200
    v_xor_b32 v202, 64, v200
    v_xor_b32 v203, 96, v200
    s_lshl_b32 s16, s28, 4
    s_mov_b32 s17, 159744
    v_add_u32 v24, s16, v1
    v_lshl_add_u32 v17, v24, 2, s17
    v_and_b32 v25, 14, v1
    v_lshlrev_b32 v26, 2, v25
    v_sub_u32 v224, v17, v26
    s_cmp_eq_u32 s28, 0
    s_cselect_b32 s18, 0, 64
    v_subrev_u32 v26, s18, v224
    v_mov_b32 v29, 0x0c0c0c0c
    v_mov_b32 v30, 0xf149f2ca
    v_cmp_gt_u32 s[52:53], 2, v25
    v_cmp_gt_u32 s[54:55], 4, v25
    s_nop 0
    v_cndmask_b32 v225, v224, v26, s[52:53]
    v_cndmask_b32 v226, v224, v26, s[54:55]
    v_cmp_gt_u32 s[52:53], 6, v25
    v_cmp_gt_u32 s[54:55], 8, v25
    s_nop 0
    v_cndmask_b32 v227, v224, v26, s[52:53]
    v_cndmask_b32 v228, v224, v26, s[54:55]
    v_cmp_gt_u32 s[52:53], 10, v25
    v_cmp_gt_u32 s[54:55], 12, v25
    s_nop 0
    v_cndmask_b32 v229, v224, v26, s[52:53]
    v_cndmask_b32 v230, v224, v26, s[54:55]
    v_cmp_gt_u32 s[52:53], 14, v25
    s_nop 1
    v_cndmask_b32 v231, v224, v26, s[52:53]
    s_cmp_eq_u32 s3, 6
    s_cbranch_scc0 L_cb1
    s_barrier
L_cb1:
    s_mov_b32 s54, 0xaaaaaaaa
    s_mov_b32 s55, 0xaaaaaaaa
    s_mov_b32 s52, 0xfff0ffff
    s_mov_b32 s53, 0xf000ff00
    v_mov_b32 v26, 0xc0c0100
    v_mov_b32 v27, 0x1000c0c
    v_cndmask_b32 v26, v26, v27, s[54:55]
    v_cndmask_b32 v234, v29, v26, s[52:53]
    v_cndmask_b32 v232, v26, v29, s[52:53]
    s_mov_b32 s52, 0xffc0fffc
    s_mov_b32 s53, 0xc000fc00
    v_mov_b32 v26, 0xc0c0302
    v_mov_b32 v27, 0x3020c0c
    v_cndmask_b32 v26, v26, v27, s[54:55]
    v_cndmask_b32 v235, v29, v26, s[52:53]
    v_cndmask_b32 v233, v26, v29, s[52:53]
    s_cmp_eq_u32 s28, 0
    s_mov_b32 s52, 0x55505555
    s_cselect_b32 s52, 0x55500000, s52
    s_mov_b32 s53, 0x50005500
    v_cndmask_b32 v204, v30, 0, s[52:53]
    s_cselect_b32 s54, 0, 0x50000
    s_cselect_b32 s55, 0, 0x5550055
    v_cndmask_b32 v208, v30, 0, s[54:55]
    s_mov_b32 s52, 0xaaa0aaaa
    s_mov_b32 s53, 0xa000aa00
    v_cndmask_b32 v205, v30, 0, s[52:53]
    s_cselect_b32 s54, 0, 0xa0000
    s_cselect_b32 s55, 0, 0xaaa00aa
    v_cndmask_b32 v209, v30, 0, s[54:55]
    s_mov_b32 s52, 0x55405554
    s_mov_b32 s53, 0x40005400
    v_cndmask_b32 v206, v30, 0, s[52:53]
    s_cselect_b32 s54, 0, 0x150001
    s_cselect_b32 s55, 0, 0x15550155
    v_cndmask_b32 v210, v30, 0, s[54:55]
    s_mov_b32 s52, 0xaa80aaa8
    s_mov_b32 s53, 0x8000a800
    v_cndmask_b32 v207, v30, 0, s[52:53]
    s_cselect_b32 s54, 0, 0x2a0002
    s_cselect_b32 s55, 0, 0x2aaa02aa
    v_cndmask_b32 v211, v30, 0, s[54:55]
    s_cmp_eq_u32 s3, 6
    s_cbranch_scc0 L_cb2
    s_barrier
    s_lshl_b32 s58, s30, 7
    s_lshl_b32 s59, s29, 2
    s_add_u32 s58, s58, s59
    s_add_u32 s58, s58, 4001792
    s_cmp_eq_u32 s26, 4
    s_cselect_b32 s58, s58, 2147418112
    v_mov_b32 v32, s56
    v_mov_b32 v33, 0
    s_waitcnt vmcnt(0)
    s_mov_b64 exec, 1
    buffer_store_dword v32, v33, s[44:47], s58 offen sc1
    s_mov_b64 exec, -1
L_cb2:
    v_lshl_add_u32 v24, v2, 1, s77
    v_and_b32 v27, 1, v0
    v_sub_u32 v28, v24, v27
    v_add_u32 v27, v24, v27
    v_add_u32 v28, 1, v28
    s_movk_i32 s18, 0x1f
    v_bfe_i32 v212, s18, v27, 1
    v_bfe_i32 v213, s18, v28, 1
    s_movk_i32 s18, 0xf80
    v_bfe_i32 v214, s18, v27, 1
    v_bfe_i32 v215, s18, v28, 1
    s_movk_i32 s18, 0x3e0
    v_bfe_i32 v216, s18, v27, 1
    v_bfe_i32 v217, s18, v28, 1
    s_movk_i32 s18, 0x3
    v_bfe_i32 v218, s18, v27, 1
    v_bfe_i32 v219, s18, v28, 1
    s_movk_i32 s18, 0x7c00
    v_bfe_i32 v220, s18, v27, 1
    v_bfe_i32 v221, s18, v28, 1
    s_movk_i32 s18, 0x7c
    v_bfe_i32 v222, s18, v27, 1
    v_bfe_i32 v223, s18, v28, 1
    s_cmp_eq_u32 s3, 6
    s_cbranch_scc0 L_cb3
    s_barrier
L_cb3:
    v_lshlrev_b32 v24, 1, v2
    v_xor_b32 v24, v24, v22
    v_lshlrev_b32 v24, 4, v24
    v_lshl_add_u32 v24, v2, 9, v24
    v_and_b32 v25, 1, v0
    v_lshl_add_u32 v24, v25, 3, v24
    v_add_u32 v9, s79, v24
    v_xor_b32 v10, 16, v9
    v_lshl_add_u32 v24, v2, 2, s16
    v_lshl_add_u32 v11, v24, 2, s17
    s_cmp_eq_u32 s29, 0
    s_cselect_b32 s18, 1, 15
    v_mul_u32_u24 v26, 1280, v24
    v_lshl_add_u32 v26, v1, 3, v26
    v_mov_b32 v27, 2147418112
    v_subrev_u32 v24, s18, v24
    v_cmp_le_i32 s[52:53], 0, v24
    v_cmp_le_i32 s[54:55], -1, v24
    s_nop 0
    v_cndmask_b32 v12, v27, v26, s[52:53]
    v_cndmask_b32 v13, v27, v26, s[54:55]
    v_cmp_le_i32 s[52:53], -2, v24
    v_cmp_le_i32 s[54:55], -3, v24
    s_nop 0
    v_cndmask_b32 v14, v27, v26, s[52:53]
    v_cndmask_b32 v15, v27, v26, s[54:55]
    v_lshlrev_b32 v26, 4, v2
    v_cmp_eq_u32 vcc, 15, v1
    s_cmp_eq_u32 s29, 0
    s_cselect_b32 s18, 1, s28
    v_cndmask_b32 v26, v27, v26, vcc
    s_cmp_eq_u32 s18, 0
    s_cselect_b64 s[52:53], -1, 0
    v_cndmask_b32 v6, v3, v26, s[52:53]
    s_mov_b64 s[52:53], 0x3ff
    v_lshlrev_b32 v26, 2, v0
    v_cndmask_b32 v16, v27, v26, s[52:53]
    s_cmp_eq_u32 s3, 1
    s_cbranch_scc1 L_ld_go
    s_cmp_eq_u32 s3, 0
    s_cbranch_scc1 L_mf
    s_cmp_eq_u32 s3, 6
    s_cbranch_scc0 L_cb4
    s_barrier
L_cb4:
L_const2:
    v_add_u32 v26, s77, v2
    v_cmp_le_u32 s[64:65], 5, v26
    v_cmp_le_u32 s[66:67], 1, v26
    v_cmp_le_u32 s[68:69], 6, v26
    v_cmp_le_u32 s[70:71], 2, v26
    v_cmp_le_u32 s[72:73], 7, v26
    v_cmp_le_u32 s[74:75], 3, v26
    s_mov_b64 s[44:45], s[24:25]
    s_mov_b32 s46, 5184512
    s_mov_b32 s47, 0x00020000
    s_mul_i32 s8, s29, 143360
    s_mul_i32 s9, s30, 14336
    s_mul_i32 s10, s29, 7
    s_add_u32 s10, s10, s28
    s_lshl_b32 s10, s10, 7
    s_add_u32 s10, s10, 4030464
    s_add_u32 s8, s8, s79
    s_lshl_b32 s11, s30, 2
    s_add_u32 s11, s11, s10
    s_add_u32 s15, s8, s9
    s_sub_u32 s4, s15, 13312
    s_add_u32 s5, s15, 14336
    v_cmp_gt_u32 vcc, 0x10000, v6
    s_nop 0
    s_mov_b64 s[6:7], vcc
    s_lshl_b32 s43, 1, s30
    s_andn2_b32 s43, 0x3ff, s43
    s_mul_i32 s14, s29, 124160
    s_lshl_b32 s9, s76, 7
    s_add_u32 s14, s14, s9
    s_add_u32 s9, s8, 143360
    s_sub_u32 s48, s20, 1280
    s_subb_u32 s49, s21, 0
    s_mov_b32 s50, 2622720
    s_mov_b32 s51, 0x00020000
    s_add_u32 s32, s15, 14336
    s_cmp_eq_u32 s32, s9
    s_cselect_b32 s32, s8, s32
    s_add_u32 s33, s32, 14336
    s_cmp_eq_u32 s33, s9
    s_cselect_b32 s33, s8, s33
    s_add_u32 s34, s33, 14336
    s_cmp_eq_u32 s34, s9
    s_cselect_b32 s34, s8, s34
    s_add_u32 s35, s34, 14336
    s_cmp_eq_u32 s35, s9
    s_cselect_b32 s35, s8, s35
    s_add_u32 s36, s35, 14336
    s_cmp_eq_u32 s36, s9
    s_cselect_b32 s36, s8, s36
    s_add_u32 s37, s36, 14336
    s_cmp_eq_u32 s37, s9
    s_cselect_b32 s37, s8, s37
    s_add_u32 s38, s37, 14336
    s_cmp_eq_u32 s38, s9
    s_cselect_b32 s38, s8, s38
    s_add_u32 s39, s38, 14336
    s_cmp_eq_u32 s39, s9
    s_cselect_b32 s39, s8, s39
    s_add_u32 s40, s39, 14336
    s_cmp_eq_u32 s40, s9
    s_cselect_b32 s40, s8, s40
    s_cmp_eq_u32 s3, 4
    s_cbranch_scc1 L_a_pre
    s_cmp_eq_u32 s3, 6
    s_cbranch_scc1 L_aux2
    s_branch L_mf_loop
L_ld_go:

    s_sub_u32 s62, s26, 6

    s_lshl_b32 s56, s62, 10

    v_subrev_u32 v46, 61440, v46
    v_subrev_u32 v47, 184320, v47
    s_add_u32 s56, s56, 38912
    s_cmp_eq_u32 s62, 0
    s_cselect_b32 s60, 0xffffff00, -1
    s_mov_b32 s61, -1
    s_mov_b32 s63, 1
    s_add_u32 s31, s31, 1
    s_cmp_eq_u32 s31, 10
    s_cselect_b32 s31, 0, s31
    s_mul_i32 s17, s76, 81920
    s_lshl_b32 s16, s62, 10
    s_add_u32 s17, s17, s16
    s_add_u32 s17, s17, 4194304
    v_lshl_add_u32 v32, v0, 4, s17
    s_lshl_b32 s64, s30, 13
    v_add_u32 v34, 2048, v32
    v_add_u32 v36, 4096, v32
    v_add_u32 v38, 6144, v32
    s_add_u32 s65, s64, 8192
    s_cmp_eq_u32 s65, 81920
    s_cselect_b32 s65, 0, s65
    s_add_u32 s66, s65, 8192
    s_cmp_eq_u32 s66, 81920
    s_cselect_b32 s66, 0, s66
    s_add_u32 s67, s66, 8192
    s_cmp_eq_u32 s67, 81920
    s_cselect_b32 s67, 0, s67
    s_mul_i32 s16, s29, 10
    s_add_u32 s16, s16, s30
    s_mul_i32 s16, s16, 14336
    v_lshlrev_b32 v41, 7, v0
    s_mul_i32 s17, s29, 896
    s_add_u32 s17, s17, 4023296
    v_add_u32 v43, s17, v41
    s_mul_i32 s17, s62, 7168
    s_add_u32 s17, s17, s16
    v_add_u32 v40, s17, v41
    v_cmp_gt_u32 vcc, 56, v0
    s_nop 1
    v_cndmask_b32 v40, v43, v40, vcc
    s_waitcnt lgkmcnt(0)
    s_mov_b64 s[44:45], s[24:25]
    s_mov_b32 s46, 5184512
    s_mov_b32 s47, 0x00020000
L_ld_loop:
    s_lshl_b32 s58, s31, 7
    s_add_u32 s58, s58, s57
    s_add_u32 m0, s56, 24576
    s_mov_b64 exec, s[60:61]
    buffer_load_dwordx4 v46, s[32:35], s58 offen  lds
    s_mov_b64 exec, -1
    s_add_u32 m0, m0, 2048
    s_add_u32 s58, s58, 20480
    buffer_load_dwordx4 v46, s[32:35], s58 offen  lds
    s_add_u32 m0, m0, 2048
    s_add_u32 s58, s58, 20480
    buffer_load_dwordx4 v46, s[32:35], s58 offen  lds
    s_add_u32 m0, m0, 2048
    s_add_u32 s58, s58, 20480
    buffer_load_dwordx4 v46, s[32:35], s58 offen  lds
    s_add_u32 m0, m0, 2048
    s_add_u32 s58, s58, 20480
    buffer_load_dwordx4 v46, s[32:35], s58 offen  lds
    s_add_u32 m0, m0, 2048
    s_add_u32 s58, s58, 20480
    buffer_load_dwordx4 v46, s[32:35], s58 offen  lds
    s_add_u32 m0, m0, 2048
    s_add_u32 s58, s58, 20480
    buffer_load_dwordx4 v46, s[32:35], s58 offen  lds
    s_mov_b32 m0, s56
    s_mul_i32 s59, s31, 245760
    buffer_load_dwordx4 v47, s[36:39], s59 offen  lds
    s_add_u32 m0, m0, 6912
    s_add_u32 s63, s63, 1
    buffer_load_dwordx4 v47, s[36:39], s59 offen offset:1280  lds
    s_add_u32 m0, m0, 6912
    s_add_u32 s31, s31, 1
    buffer_load_dwordx4 v47, s[36:39], s59 offen offset:2560  lds
    s_sub_u32 m0, m0, 11776
    s_add_u32 s59, s59, 61440
    buffer_load_dwordx4 v47, s[36:39], s59 offen  lds
    s_add_u32 m0, m0, 6912
    s_cmp_eq_u32 s31, 10
    s_cselect_b32 s31, 0, s31
    buffer_load_dwordx4 v47, s[36:39], s59 offen offset:1280  lds
    s_add_u32 m0, m0, 6912
    s_add_u32 s56, s56, 38912
    buffer_load_dwordx4 v47, s[36:39], s59 offen offset:2560  lds
    s_sub_u32 m0, m0, 11776
    s_add_u32 s59, s59, 61440
    buffer_load_dwordx4 v47, s[36:39], s59 offen  lds
    s_add_u32 m0, m0, 6912
    s_cmp_ge_u32 s56, 116736
    s_cselect_b32 s19, 116736, 0
    buffer_load_dwordx4 v47, s[36:39], s59 offen offset:1280  lds
    s_add_u32 m0, m0, 6912
    s_sub_u32 s56, s56, s19
    buffer_load_dwordx4 v47, s[36:39], s59 offen offset:2560  lds
    s_waitcnt vmcnt(16)
    s_barrier
    s_sub_u32 m0, m0, 11776
    s_add_u32 s59, s59, 61440
    buffer_load_dwordx4 v47, s[36:39], s59 offen  lds
    s_add_u32 m0, m0, 6912
    s_nop 0
    buffer_load_dwordx4 v47, s[36:39], s59 offen offset:1280  lds
    s_add_u32 m0, m0, 6912
    s_nop 0
    buffer_load_dwordx4 v47, s[36:39], s59 offen offset:2560  lds
    s_cmp_lt_u32 s63, 10
    s_cbranch_scc1 L_ld_loop
    s_lshl_b32 s58, s62, 10
    s_add_u32 m0, s58, 38912
    s_nop 0
    buffer_load_dwordx4 v32, s[44:47], s64 offen sc1 lds
    s_add_u32 m0, m0, 2048
    s_nop 0
    buffer_load_dwordx4 v34, s[44:47], s64 offen sc1 lds
    s_add_u32 m0, m0, 2048
    s_nop 0
    buffer_load_dwordx4 v36, s[44:47], s64 offen sc1 lds
    s_add_u32 m0, m0, 2048
    s_nop 0
    buffer_load_dwordx4 v38, s[44:47], s64 offen sc1 lds
    s_add_u32 m0, m0, 2048
    s_nop 0
    buffer_load_dwordx4 v32, s[44:47], s65 offen sc1 lds
    s_add_u32 m0, m0, 2048
    s_nop 0
    buffer_load_dwordx4 v34, s[44:47], s65 offen sc1 lds
    s_add_u32 m0, m0, 2048
    s_nop 0
    buffer_load_dwordx4 v36, s[44:47], s65 offen sc1 lds
    s_add_u32 m0, m0, 2048
    s_nop 0
    buffer_load_dwordx4 v38, s[44:47], s65 offen sc1 lds
    s_add_u32 m0, m0, 2048
    s_nop 0
    buffer_load_dwordx4 v32, s[44:47], s66 offen sc1 lds
    s_add_u32 m0, m0, 2048
    s_nop 0
    buffer_load_dwordx4 v34, s[44:47], s66 offen sc1 lds
    s_add_u32 m0, m0, 2048
    s_nop 0
    buffer_load_dwordx4 v36, s[44:47], s66 offen sc1 lds
    s_add_u32 m0, m0, 2048
    s_nop 0
    buffer_load_dwordx4 v38, s[44:47], s66 offen sc1 lds
    s_add_u32 m0, m0, 2048
    s_nop 0
    buffer_load_dwordx4 v32, s[44:47], s67 offen sc1 lds
    s_add_u32 m0, m0, 2048
    s_nop 0
    buffer_load_dwordx4 v34, s[44:47], s67 offen sc1 lds
    s_add_u32 m0, m0, 2048
    s_nop 0
    buffer_load_dwordx4 v36, s[44:47], s67 offen sc1 lds
    s_add_u32 m0, m0, 2048
    s_nop 0
    buffer_load_dwordx4 v38, s[44:47], s67 offen sc1 lds
    s_waitcnt vmcnt(16)
    s_barrier
    buffer_load_dword v107, v40, s[44:47], 0 offen
    s_setprio 0
    s_mov_b32 s3, 4
    s_branch L_const2
L_mf:
    s_add_u32 s58, s79, 92160
    v_subrev_u32 v20, s58, v198
    v_subrev_u32 v21, s58, v199
    v_bfe_u32 v25, v0, 2, 2
    v_lshl_add_u32 v26, v2, 3, v25
    v_lshlrev_b32 v26, 7, v26
    v_lshrrev_b32 v25, 1, v25
    v_and_b32 v27, 1, v2
    v_lshl_add_u32 v25, v27, 1, v25
    v_xor_b32 v25, s26, v25
    v_lshl_add_u32 v26, v25, 5, v26
    v_and_b32 v25, 3, v0
    v_lshl_add_u32 v22, v25, 3, v26
    s_lshl_b32 s58, s26, 5
    s_sub_u32 s59, 116736, s79
    v_xor_b32 v23, s58, v8
    v_add_u32 v23, s59, v23
    v_and_b32 v29, 1, v0
    v_lshlrev_b32 v29, 3, v29
    v_xor_b32 v23, v23, v29
    v_bfe_u32 v25, v1, 1, 2
    v_xor_b32 v25, s26, v25
    v_lshlrev_b32 v25, 5, v25
    v_lshl_add_u32 v25, v1, 7, v25
    v_lshrrev_b32 v26, 1, v2
    v_lshrrev_b32 v28, 3, v1
    v_xor_b32 v26, v26, v28
    v_lshl_add_u32 v25, v26, 4, v25
    v_lshl_add_u32 v25, v27, 3, v25
    v_xor_b32 v25, v25, v29
    v_add_u32 v24, 116736, v25
    v_lshlrev_b32 v25, 2, v1
    v_add_u32 v25, 159744, v25
    s_mov_b32 s63, 0
    s_mov_b32 s56, 0
    s_mov_b32 s60, 38912
    s_waitcnt vmcnt(0)
    s_barrier
    ds_read_b64_tr_b16 v[116:117], v22 offset:0
    ds_read_b64_tr_b16 v[118:119], v22 offset:512
    ds_read_b64_tr_b16 v[120:121], v22 offset:8192
    ds_read_b64_tr_b16 v[122:123], v22 offset:8704
    ds_read_b64_tr_b16 v[124:125], v22 offset:16384
    ds_read_b64_tr_b16 v[126:127], v22 offset:16896
    ds_read_b128 v[140:143], v20 offset:0
    ds_read_b128 v[144:147], v20 offset:2048
    ds_read_b128 v[148:151], v20 offset:4096
    ds_read_b128 v[152:155], v20 offset:6144
    ds_read_b128 v[156:159], v20 offset:8192
    ds_read_b128 v[160:163], v20 offset:10240
    ds_read_b128 v[164:167], v20 offset:12288
    s_mov_b32 s56, 1
    s_mov_b32 s58, s60
    s_mov_b32 s63, 1
    s_waitcnt lgkmcnt(0)
    v_mfma_f32_16x16x32_bf16 v[32:35], v[116:119], v[140:143], 0
    ds_read_b64_tr_b16 v[128:129], v22 offset:4096
    v_mfma_f32_16x16x32_bf16 v[36:39], v[120:123], v[140:143], 0
    ds_read_b64_tr_b16 v[130:131], v22 offset:4608
    v_mfma_f32_16x16x32_bf16 v[40:43], v[124:127], v[140:143], 0
    ds_read_b64_tr_b16 v[132:133], v22 offset:12288
    v_mfma_f32_16x16x32_bf16 v[44:47], v[116:119], v[144:147], 0
    ds_read_b64_tr_b16 v[134:135], v22 offset:12800
    v_mfma_f32_16x16x32_bf16 v[48:51], v[120:123], v[144:147], 0
    ds_read_b64_tr_b16 v[136:137], v22 offset:20480
    v_mfma_f32_16x16x32_bf16 v[52:55], v[124:127], v[144:147], 0
    ds_read_b64_tr_b16 v[138:139], v22 offset:20992
    v_mfma_f32_16x16x32_bf16 v[56:59], v[116:119], v[148:151], 0
    ds_read_b128 v[168:171], v21 offset:0
    v_mfma_f32_16x16x32_bf16 v[60:63], v[120:123], v[148:151], 0
    ds_read_b128 v[172:175], v21 offset:2048
    v_mfma_f32_16x16x32_bf16 v[64:67], v[124:127], v[148:151], 0
    ds_read_b128 v[176:179], v21 offset:4096
    v_mfma_f32_16x16x32_bf16 v[68:71], v[116:119], v[152:155], 0
    ds_read_b128 v[180:183], v21 offset:6144
    v_mfma_f32_16x16x32_bf16 v[72:75], v[120:123], v[152:155], 0
    ds_read_b128 v[184:187], v21 offset:8192
    v_mfma_f32_16x16x32_bf16 v[76:79], v[124:127], v[152:155], 0
    ds_read_b128 v[188:191], v21 offset:10240
    v_mfma_f32_16x16x32_bf16 v[80:83], v[116:119], v[156:159], 0
    ds_read_b128 v[192:195], v21 offset:12288
    v_mfma_f32_16x16x32_bf16 v[84:87], v[120:123], v[156:159], 0
    v_add_u32 v20, s58, v20
    v_mfma_f32_16x16x32_bf16 v[88:91], v[124:127], v[156:159], 0
    v_add_u32 v21, s58, v21
    v_mfma_f32_16x16x32_bf16 v[92:95], v[116:119], v[160:163], 0
    v_add_u32 v22, s58, v22
    v_mfma_f32_16x16x32_bf16 v[96:99], v[120:123], v[160:163], 0
    v_mfma_f32_16x16x32_bf16 v[100:103], v[124:127], v[160:163], 0
    v_mfma_f32_16x16x32_bf16 v[104:107], v[116:119], v[164:167], 0
    v_mfma_f32_16x16x32_bf16 v[108:111], v[120:123], v[164:167], 0
    v_mfma_f32_16x16x32_bf16 v[112:115], v[124:127], v[164:167], 0
    s_waitcnt lgkmcnt(0)
    s_branch L_const2
L_mf_loop:
    s_barrier
    ds_read_b64_tr_b16 v[116:117], v22 offset:0
    ds_read_b64_tr_b16 v[118:119], v22 offset:512
    v_mfma_f32_16x16x32_bf16 v[32:35], v[128:131], v[168:171], v[32:35]
    ds_read_b64_tr_b16 v[120:121], v22 offset:8192
    v_mfma_f32_16x16x32_bf16 v[36:39], v[132:135], v[168:171], v[36:39]
    ds_read_b64_tr_b16 v[122:123], v22 offset:8704
    v_mfma_f32_16x16x32_bf16 v[40:43], v[136:139], v[168:171], v[40:43]
    ds_read_b64_tr_b16 v[124:125], v22 offset:16384
    v_mfma_f32_16x16x32_bf16 v[44:47], v[128:131], v[172:175], v[44:47]
    ds_read_b64_tr_b16 v[126:127], v22 offset:16896
    v_mfma_f32_16x16x32_bf16 v[48:51], v[132:135], v[172:175], v[48:51]
    ds_read_b128 v[140:143], v20 offset:0
    v_mfma_f32_16x16x32_bf16 v[52:55], v[136:139], v[172:175], v[52:55]
    ds_read_b128 v[144:147], v20 offset:2048
    v_mfma_f32_16x16x32_bf16 v[56:59], v[128:131], v[176:179], v[56:59]
    ds_read_b128 v[148:151], v20 offset:4096
    v_mfma_f32_16x16x32_bf16 v[60:63], v[132:135], v[176:179], v[60:63]
    ds_read_b128 v[152:155], v20 offset:6144
    v_mfma_f32_16x16x32_bf16 v[64:67], v[136:139], v[176:179], v[64:67]
    ds_read_b128 v[156:159], v20 offset:8192
    v_mfma_f32_16x16x32_bf16 v[68:71], v[128:131], v[180:183], v[68:71]
    ds_read_b128 v[160:163], v20 offset:10240
    v_mfma_f32_16x16x32_bf16 v[72:75], v[132:135], v[180:183], v[72:75]
    ds_read_b128 v[164:167], v20 offset:12288
    v_mfma_f32_16x16x32_bf16 v[76:79], v[136:139], v[180:183], v[76:79]
    s_add_u32 s56, s56, 1
    v_mfma_f32_16x16x32_bf16 v[80:83], v[128:131], v[184:187], v[80:83]
    s_cmp_eq_u32 s56, 3
    v_mfma_f32_16x16x32_bf16 v[84:87], v[132:135], v[184:187], v[84:87]
    s_cselect_b32 s58, 0xfffed000, s60
    v_mfma_f32_16x16x32_bf16 v[88:91], v[136:139], v[184:187], v[88:91]
    s_cselect_b32 s56, 0, s56
    v_mfma_f32_16x16x32_bf16 v[92:95], v[128:131], v[188:191], v[92:95]
    s_add_u32 s63, s63, 1
    v_mfma_f32_16x16x32_bf16 v[96:99], v[132:135], v[188:191], v[96:99]
    v_mfma_f32_16x16x32_bf16 v[100:103], v[136:139], v[188:191], v[100:103]
    v_mfma_f32_16x16x32_bf16 v[104:107], v[128:131], v[192:195], v[104:107]
    v_mfma_f32_16x16x32_bf16 v[108:111], v[132:135], v[192:195], v[108:111]
    v_mfma_f32_16x16x32_bf16 v[112:115], v[136:139], v[192:195], v[112:115]
L_mf_mid:
    s_waitcnt lgkmcnt(0)
    v_mfma_f32_16x16x32_bf16 v[32:35], v[116:119], v[140:143], v[32:35]
    ds_read_b64_tr_b16 v[128:129], v22 offset:4096
    v_mfma_f32_16x16x32_bf16 v[36:39], v[120:123], v[140:143], v[36:39]
    ds_read_b64_tr_b16 v[130:131], v22 offset:4608
    v_mfma_f32_16x16x32_bf16 v[40:43], v[124:127], v[140:143], v[40:43]
    ds_read_b64_tr_b16 v[132:133], v22 offset:12288
    v_mfma_f32_16x16x32_bf16 v[44:47], v[116:119], v[144:147], v[44:47]
    ds_read_b64_tr_b16 v[134:135], v22 offset:12800
    v_mfma_f32_16x16x32_bf16 v[48:51], v[120:123], v[144:147], v[48:51]
    ds_read_b64_tr_b16 v[136:137], v22 offset:20480
    v_mfma_f32_16x16x32_bf16 v[52:55], v[124:127], v[144:147], v[52:55]
    ds_read_b64_tr_b16 v[138:139], v22 offset:20992
    v_mfma_f32_16x16x32_bf16 v[56:59], v[116:119], v[148:151], v[56:59]
    ds_read_b128 v[168:171], v21 offset:0
    v_mfma_f32_16x16x32_bf16 v[60:63], v[120:123], v[148:151], v[60:63]
    ds_read_b128 v[172:175], v21 offset:2048
    v_mfma_f32_16x16x32_bf16 v[64:67], v[124:127], v[148:151], v[64:67]
    ds_read_b128 v[176:179], v21 offset:4096
    v_mfma_f32_16x16x32_bf16 v[68:71], v[116:119], v[152:155], v[68:71]
    ds_read_b128 v[180:183], v21 offset:6144
    v_mfma_f32_16x16x32_bf16 v[72:75], v[120:123], v[152:155], v[72:75]
    ds_read_b128 v[184:187], v21 offset:8192
    v_mfma_f32_16x16x32_bf16 v[76:79], v[124:127], v[152:155], v[76:79]
    ds_read_b128 v[188:191], v21 offset:10240
    v_mfma_f32_16x16x32_bf16 v[80:83], v[116:119], v[156:159], v[80:83]
    ds_read_b128 v[192:195], v21 offset:12288
    v_mfma_f32_16x16x32_bf16 v[84:87], v[120:123], v[156:159], v[84:87]
    v_add_u32 v20, s58, v20
    v_mfma_f32_16x16x32_bf16 v[88:91], v[124:127], v[156:159], v[88:91]
    v_add_u32 v21, s58, v21
    v_mfma_f32_16x16x32_bf16 v[92:95], v[116:119], v[160:163], v[92:95]
    v_add_u32 v22, s58, v22
    v_mfma_f32_16x16x32_bf16 v[96:99], v[120:123], v[160:163], v[96:99]
    s_cmp_lt_u32 s63, 9
    v_mfma_f32_16x16x32_bf16 v[100:103], v[124:127], v[160:163], v[100:103]
    v_mfma_f32_16x16x32_bf16 v[104:107], v[116:119], v[164:167], v[104:107]
    v_mfma_f32_16x16x32_bf16 v[108:111], v[120:123], v[164:167], v[108:111]
    v_mfma_f32_16x16x32_bf16 v[112:115], v[124:127], v[164:167], v[112:115]
    s_waitcnt lgkmcnt(0)
    s_cbranch_scc1 L_mf_loop
    s_waitcnt vmcnt(0)
    v_mfma_f32_16x16x32_bf16 v[32:35], v[128:131], v[168:171], v[32:35]
    ds_read_b32 v248, v25 offset:0
    v_mfma_f32_16x16x32_bf16 v[36:39], v[132:135], v[168:171], v[36:39]
    ds_read_b32 v249, v25 offset:64
    v_mfma_f32_16x16x32_bf16 v[40:43], v[136:139], v[168:171], v[40:43]
    ds_read_b32 v250, v25 offset:128
    v_mfma_f32_16x16x32_bf16 v[44:47], v[128:131], v[172:175], v[44:47]
    ds_read_b32 v251, v25 offset:192
    v_mfma_f32_16x16x32_bf16 v[48:51], v[132:135], v[172:175], v[48:51]
    ds_read_b32 v252, v25 offset:256
    v_mfma_f32_16x16x32_bf16 v[52:55], v[136:139], v[172:175], v[52:55]
    ds_read_b32 v253, v25 offset:320
    v_mfma_f32_16x16x32_bf16 v[56:59], v[128:131], v[176:179], v[56:59]
    ds_read_b32 v254, v25 offset:384
    v_mfma_f32_16x16x32_bf16 v[60:63], v[132:135], v[176:179], v[60:63]
    v_mov_b32 v30, 160768
    v_mfma_f32_16x16x32_bf16 v[64:67], v[136:139], v[176:179], v[64:67]
    ds_read_b64 v[28:29], v30
    v_mfma_f32_16x16x32_bf16 v[68:71], v[128:131], v[180:183], v[68:71]
    ds_read_b32 v18, v17 offset:512
    v_mfma_f32_16x16x32_bf16 v[72:75], v[132:135], v[180:183], v[72:75]
    ds_read_b32 v224, v224 offset:512
    v_mfma_f32_16x16x32_bf16 v[76:79], v[136:139], v[180:183], v[76:79]
    ds_read_b32 v225, v225 offset:520
    v_mfma_f32_16x16x32_bf16 v[80:83], v[128:131], v[184:187], v[80:83]
    ds_read_b32 v226, v226 offset:528
    v_mfma_f32_16x16x32_bf16 v[84:87], v[132:135], v[184:187], v[84:87]
    ds_read_b32 v227, v227 offset:536
    v_mfma_f32_16x16x32_bf16 v[88:91], v[136:139], v[184:187], v[88:91]
    ds_read_b32 v228, v228 offset:544
    v_mfma_f32_16x16x32_bf16 v[92:95], v[128:131], v[188:191], v[92:95]
    ds_read_b32 v229, v229 offset:552
    v_mfma_f32_16x16x32_bf16 v[96:99], v[132:135], v[188:191], v[96:99]
    ds_read_b32 v230, v230 offset:560
    v_mfma_f32_16x16x32_bf16 v[100:103], v[136:139], v[188:191], v[100:103]
    ds_read_b32 v231, v231 offset:568
    v_mfma_f32_16x16x32_bf16 v[104:107], v[128:131], v[192:195], v[104:107]
    v_mfma_f32_16x16x32_bf16 v[108:111], v[132:135], v[192:195], v[108:111]
    v_mfma_f32_16x16x32_bf16 v[112:115], v[136:139], v[192:195], v[112:115]
    s_waitcnt lgkmcnt(0)
    s_barrier
    ds_read_b64_tr_b16 v[116:117], v22 offset:0
    ds_read_b64_tr_b16 v[118:119], v22 offset:512
    ds_read_b128 v[140:143], v20 offset:0
    ds_read_b64_tr_b16 v[120:121], v22 offset:8192
    ds_read_b64_tr_b16 v[122:123], v22 offset:8704
    ds_read_b64_tr_b16 v[124:125], v22 offset:16384
    ds_read_b64_tr_b16 v[126:127], v22 offset:16896
    ds_read_b128 v[168:171], v21 offset:0
    ds_read_b64_tr_b16 v[128:129], v22 offset:4096
    ds_read_b64_tr_b16 v[130:131], v22 offset:4608
    ds_read_b64_tr_b16 v[132:133], v22 offset:12288
    ds_read_b64_tr_b16 v[134:135], v22 offset:12800
    ds_read_b64_tr_b16 v[136:137], v22 offset:20480
    ds_read_b64_tr_b16 v[138:139], v22 offset:20992
    s_waitcnt lgkmcnt(11)
    v_mfma_f32_16x16x32_bf16 v[32:35], v[116:119], v[140:143], v[32:35]
    ds_read_b128 v[144:147], v20 offset:2048
    s_waitcnt lgkmcnt(10)
    v_mfma_f32_16x16x32_bf16 v[36:39], v[120:123], v[140:143], v[36:39]
    ds_read_b128 v[172:175], v21 offset:2048
    s_waitcnt lgkmcnt(9)
    v_mfma_f32_16x16x32_bf16 v[40:43], v[124:127], v[140:143], v[40:43]
    ds_read_b128 v[148:151], v20 offset:4096
    s_waitcnt lgkmcnt(7)
    v_mfma_f32_16x16x32_bf16 v[32:35], v[128:131], v[168:171], v[32:35]
    ds_read_b128 v[176:179], v21 offset:4096
    s_waitcnt lgkmcnt(6)
    v_mfma_f32_16x16x32_bf16 v[36:39], v[132:135], v[168:171], v[36:39]
    ds_read_b128 v[152:155], v20 offset:6144
    s_waitcnt lgkmcnt(5)
    v_mfma_f32_16x16x32_bf16 v[40:43], v[136:139], v[168:171], v[40:43]
    ds_read_b128 v[180:183], v21 offset:6144
    s_waitcnt lgkmcnt(5)
    v_mfma_f32_16x16x32_bf16 v[44:47], v[116:119], v[144:147], v[44:47]
    ds_read_b128 v[156:159], v20 offset:8192
    v_mfma_f32_16x16x32_bf16 v[48:51], v[120:123], v[144:147], v[48:51]
    ds_read_b128 v[184:187], v21 offset:8192
    v_mfma_f32_16x16x32_bf16 v[52:55], v[124:127], v[144:147], v[52:55]
    ds_read_b128 v[160:163], v20 offset:10240
    v_mov_b32_dpp v236, v32 row_newbcast:0 row_mask:0xf bank_mask:0xf
    v_mov_b32_dpp v237, v33 row_newbcast:0 row_mask:0xf bank_mask:0xf
    v_mov_b32_dpp v238, v34 row_newbcast:0 row_mask:0xf bank_mask:0xf
    v_mov_b32_dpp v239, v35 row_newbcast:0 row_mask:0xf bank_mask:0xf
    s_waitcnt lgkmcnt(7)
    v_mfma_f32_16x16x32_bf16 v[44:47], v[128:131], v[172:175], v[44:47]
    ds_read_b128 v[188:191], v21 offset:10240
    v_fmac_f32 v32, v236, v248
    v_fmac_f32 v33, v237, v248
    v_fmac_f32 v34, v238, v248
    v_fmac_f32 v35, v239, v248
    v_mfma_f32_16x16x32_bf16 v[48:51], v[132:135], v[172:175], v[48:51]
    ds_read_b128 v[164:167], v20 offset:12288
    v_cvt_pk_bf16_f32 v32, v32, v33
    v_cvt_pk_bf16_f32 v33, v34, v35
    ds_write_b64 v23, v[32:33] offset:0
    v_mov_b32_dpp v240, v36 row_newbcast:0 row_mask:0xf bank_mask:0xf
    v_mfma_f32_16x16x32_bf16 v[52:55], v[136:139], v[172:175], v[52:55]
    ds_read_b128 v[192:195], v21 offset:12288
    v_mov_b32_dpp v241, v37 row_newbcast:0 row_mask:0xf bank_mask:0xf
    v_mov_b32_dpp v242, v38 row_newbcast:0 row_mask:0xf bank_mask:0xf
    v_mov_b32_dpp v243, v39 row_newbcast:0 row_mask:0xf bank_mask:0xf
    v_fmac_f32 v36, v240, v248
    s_waitcnt lgkmcnt(10)
    v_mfma_f32_16x16x32_bf16 v[56:59], v[116:119], v[148:151], v[56:59]
    v_fmac_f32 v37, v241, v248
    v_fmac_f32 v38, v242, v248
    v_fmac_f32 v39, v243, v248
    v_cvt_pk_bf16_f32 v36, v36, v37
    v_mfma_f32_16x16x32_bf16 v[60:63], v[120:123], v[148:151], v[60:63]
    v_cvt_pk_bf16_f32 v37, v38, v39
    ds_write_b64 v23, v[36:37] offset:14336
    v_mov_b32_dpp v244, v40 row_newbcast:0 row_mask:0xf bank_mask:0xf
    v_mov_b32_dpp v245, v41 row_newbcast:0 row_mask:0xf bank_mask:0xf
    v_mfma_f32_16x16x32_bf16 v[64:67], v[124:127], v[148:151], v[64:67]
    v_mov_b32_dpp v246, v42 row_newbcast:0 row_mask:0xf bank_mask:0xf
    v_mov_b32_dpp v247, v43 row_newbcast:0 row_mask:0xf bank_mask:0xf
    v_fmac_f32 v40, v244, v248
    v_fmac_f32 v41, v245, v248
    s_waitcnt lgkmcnt(10)
    v_mfma_f32_16x16x32_bf16 v[56:59], v[128:131], v[176:179], v[56:59]
    v_fmac_f32 v42, v246, v248
    v_fmac_f32 v43, v247, v248
    v_cvt_pk_bf16_f32 v40, v40, v41
    v_cvt_pk_bf16_f32 v41, v42, v43
    v_mfma_f32_16x16x32_bf16 v[60:63], v[132:135], v[176:179], v[60:63]
    ds_write_b64 v24, v[40:41] offset:28672
    v_fmac_f32 v44, v236, v249
    v_fmac_f32 v45, v237, v249
    v_fmac_f32 v46, v238, v249
    v_mfma_f32_16x16x32_bf16 v[64:67], v[136:139], v[176:179], v[64:67]
    v_fmac_f32 v47, v239, v249
    v_cvt_pk_bf16_f32 v44, v44, v45
    v_cvt_pk_bf16_f32 v45, v46, v47
    ds_write_b64 v23, v[44:45] offset:2048
    s_waitcnt lgkmcnt(11)
    v_mfma_f32_16x16x32_bf16 v[68:71], v[116:119], v[152:155], v[68:71]
    v_fmac_f32 v48, v240, v249
    v_fmac_f32 v49, v241, v249
    v_fmac_f32 v50, v242, v249
    v_fmac_f32 v51, v243, v249
    v_mfma_f32_16x16x32_bf16 v[72:75], v[120:123], v[152:155], v[72:75]
    v_cvt_pk_bf16_f32 v48, v48, v49
    v_cvt_pk_bf16_f32 v49, v50, v51
    ds_write_b64 v23, v[48:49] offset:16384
    v_fmac_f32 v52, v244, v249
    v_mfma_f32_16x16x32_bf16 v[76:79], v[124:127], v[152:155], v[76:79]
    v_fmac_f32 v53, v245, v249
    v_fmac_f32 v54, v246, v249
    v_fmac_f32 v55, v247, v249
    v_cvt_pk_bf16_f32 v52, v52, v53
    s_waitcnt lgkmcnt(11)
    v_mfma_f32_16x16x32_bf16 v[68:71], v[128:131], v[180:183], v[68:71]
    v_cvt_pk_bf16_f32 v53, v54, v55
    ds_write_b64 v24, v[52:53] offset:30720
    v_fmac_f32 v56, v236, v250
    v_fmac_f32 v57, v237, v250
    v_mfma_f32_16x16x32_bf16 v[72:75], v[132:135], v[180:183], v[72:75]
    v_fmac_f32 v58, v238, v250
    v_fmac_f32 v59, v239, v250
    v_cvt_pk_bf16_f32 v56, v56, v57
    v_cvt_pk_bf16_f32 v57, v58, v59
    v_mfma_f32_16x16x32_bf16 v[76:79], v[136:139], v[180:183], v[76:79]
    ds_write_b64 v23, v[56:57] offset:4096
    v_fmac_f32 v60, v240, v250
    v_fmac_f32 v61, v241, v250
    v_fmac_f32 v62, v242, v250
    s_waitcnt lgkmcnt(12)
    v_mfma_f32_16x16x32_bf16 v[80:83], v[116:119], v[156:159], v[80:83]
    v_fmac_f32 v63, v243, v250
    v_cvt_pk_bf16_f32 v60, v60, v61
    v_cvt_pk_bf16_f32 v61, v62, v63
    ds_write_b64 v23, v[60:61] offset:18432
    v_mfma_f32_16x16x32_bf16 v[84:87], v[120:123], v[156:159], v[84:87]
    v_fmac_f32 v64, v244, v250
    v_fmac_f32 v65, v245, v250
    v_fmac_f32 v66, v246, v250
    v_fmac_f32 v67, v247, v250
    v_mfma_f32_16x16x32_bf16 v[88:91], v[124:127], v[156:159], v[88:91]
    v_cvt_pk_bf16_f32 v64, v64, v65
    v_cvt_pk_bf16_f32 v65, v66, v67
    ds_write_b64 v24, v[64:65] offset:32768
    v_fmac_f32 v68, v236, v251
    s_waitcnt lgkmcnt(13)
    v_mfma_f32_16x16x32_bf16 v[80:83], v[128:131], v[184:187], v[80:83]
    v_fmac_f32 v69, v237, v251
    v_fmac_f32 v70, v238, v251
    v_fmac_f32 v71, v239, v251
    v_cvt_pk_bf16_f32 v68, v68, v69
    v_mfma_f32_16x16x32_bf16 v[84:87], v[132:135], v[184:187], v[84:87]
    v_cvt_pk_bf16_f32 v69, v70, v71
    ds_write_b64 v23, v[68:69] offset:6144
    v_fmac_f32 v72, v240, v251
    v_fmac_f32 v73, v241, v251
    v_mfma_f32_16x16x32_bf16 v[88:91], v[136:139], v[184:187], v[88:91]
    v_fmac_f32 v74, v242, v251
    v_fmac_f32 v75, v243, v251
    v_cvt_pk_bf16_f32 v72, v72, v73
    v_cvt_pk_bf16_f32 v73, v74, v75
    s_waitcnt lgkmcnt(13)
    v_mfma_f32_16x16x32_bf16 v[92:95], v[116:119], v[160:163], v[92:95]
    ds_write_b64 v23, v[72:73] offset:20480
    v_fmac_f32 v76, v244, v251
    v_fmac_f32 v77, v245, v251
    v_fmac_f32 v78, v246, v251
    v_mfma_f32_16x16x32_bf16 v[96:99], v[120:123], v[160:163], v[96:99]
    v_fmac_f32 v79, v247, v251
    v_cvt_pk_bf16_f32 v76, v76, v77
    v_cvt_pk_bf16_f32 v77, v78, v79
    ds_write_b64 v24, v[76:77] offset:34816
    v_mfma_f32_16x16x32_bf16 v[100:103], v[124:127], v[160:163], v[100:103]
    v_fmac_f32 v80, v236, v252
    v_fmac_f32 v81, v237, v252
    v_fmac_f32 v82, v238, v252
    v_fmac_f32 v83, v239, v252
    s_waitcnt lgkmcnt(14)
    v_mfma_f32_16x16x32_bf16 v[92:95], v[128:131], v[188:191], v[92:95]
    v_cvt_pk_bf16_f32 v80, v80, v81
    v_cvt_pk_bf16_f32 v81, v82, v83
    ds_write_b64 v23, v[80:81] offset:8192
    v_fmac_f32 v84, v240, v252
    v_mfma_f32_16x16x32_bf16 v[96:99], v[132:135], v[188:191], v[96:99]
    v_fmac_f32 v85, v241, v252
    s_waitcnt lgkmcnt(1)
    s_barrier
    v_fmac_f32 v86, v242, v252
    v_fmac_f32 v87, v243, v252
    v_cvt_pk_bf16_f32 v84, v84, v85
    v_mfma_f32_16x16x32_bf16 v[100:103], v[136:139], v[188:191], v[100:103]
    v_cvt_pk_bf16_f32 v85, v86, v87
    ds_write_b64 v23, v[84:85] offset:22528
    v_fmac_f32 v88, v244, v252
    v_fmac_f32 v89, v245, v252
    s_waitcnt lgkmcnt(15)
    v_mfma_f32_16x16x32_bf16 v[104:107], v[116:119], v[164:167], v[104:107]
    v_fmac_f32 v90, v246, v252
    v_fmac_f32 v91, v247, v252
    v_cvt_pk_bf16_f32 v88, v88, v89
    v_cvt_pk_bf16_f32 v89, v90, v91
    v_mfma_f32_16x16x32_bf16 v[108:111], v[120:123], v[164:167], v[108:111]
    ds_write_b64 v24, v[88:89] offset:36864
    v_fmac_f32 v92, v236, v253
    v_fmac_f32 v93, v237, v253
    v_fmac_f32 v94, v238, v253
    v_mfma_f32_16x16x32_bf16 v[112:115], v[124:127], v[164:167], v[112:115]
    v_fmac_f32 v95, v239, v253
    v_cvt_pk_bf16_f32 v92, v92, v93
    v_cvt_pk_bf16_f32 v93, v94, v95
    ds_write_b64 v23, v[92:93] offset:10240
    s_waitcnt lgkmcnt(15)
    v_mfma_f32_16x16x32_bf16 v[104:107], v[128:131], v[192:195], v[104:107]
    v_fmac_f32 v96, v240, v253
    v_fmac_f32 v97, v241, v253
    v_fmac_f32 v98, v242, v253
    v_fmac_f32 v99, v243, v253
    v_mfma_f32_16x16x32_bf16 v[108:111], v[132:135], v[192:195], v[108:111]
    v_cvt_pk_bf16_f32 v96, v96, v97
    v_cvt_pk_bf16_f32 v97, v98, v99
    ds_write_b64 v23, v[96:97] offset:24576
    v_fmac_f32 v100, v244, v253
    v_mfma_f32_16x16x32_bf16 v[112:115], v[136:139], v[192:195], v[112:115]
    v_fmac_f32 v101, v245, v253
    v_fmac_f32 v102, v246, v253
    v_fmac_f32 v103, v247, v253
    v_cvt_pk_bf16_f32 v100, v100, v101
    v_cvt_pk_bf16_f32 v101, v102, v103
    ds_write_b64 v24, v[100:101] offset:38912
    v_fmac_f32 v104, v236, v254
    v_fmac_f32 v105, v237, v254
    v_fmac_f32 v106, v238, v254
    v_fmac_f32 v107, v239, v254
    v_cvt_pk_bf16_f32 v104, v104, v105
    v_cvt_pk_bf16_f32 v105, v106, v107
    ds_write_b64 v23, v[104:105] offset:12288
    v_fmac_f32 v108, v240, v254
    v_fmac_f32 v109, v241, v254
    v_fmac_f32 v110, v242, v254
    v_fmac_f32 v111, v243, v254
    v_cvt_pk_bf16_f32 v108, v108, v109
    v_cvt_pk_bf16_f32 v109, v110, v111
    ds_write_b64 v23, v[108:109] offset:26624
    v_fmac_f32 v112, v244, v254
    v_fmac_f32 v113, v245, v254
    v_fmac_f32 v114, v246, v254
    v_fmac_f32 v115, v247, v254
    v_cvt_pk_bf16_f32 v112, v112, v113
    v_cvt_pk_bf16_f32 v113, v114, v115
    ds_write_b64 v24, v[112:113] offset:40960
    v_mov_b32 v26, 1
    s_mov_b64 exec, 1
    ds_add_rtn_u32 v27, v30, v26 offset:36
    s_mov_b64 exec, -1
    s_mov_b32 s63, 0
    s_waitcnt lgkmcnt(0)
    v_readfirstlane_b32 s58, v27
    s_nop 0
    s_cmp_ge_u32 s58, 3
    s_cbranch_scc1 L_bb_ok
L_bb:
    ds_read_b32 v27, v30 offset:36
    s_add_u32 s63, s63, 1
    s_waitcnt lgkmcnt(0)
    v_readfirstlane_b32 s58, v27
    s_cmp_ge_u32 s63, 800000
    s_cbranch_scc1 L_bb_ok
    s_cmp_ge_u32 s58, 4
    s_cbranch_scc0 L_bb
L_bb_ok:
    s_cmp_eq_u32 s26, 3
    s_cbranch_scc1 L_w3
    s_branch L_att_disp
L_a_pre:
    v_mov_b32 v30, 160768
    ds_read_b64 v[28:29], v30
    ds_read_b32 v18, v17 offset:512
    ds_read_b32 v224, v224 offset:512
    ds_read_b32 v225, v225 offset:520
    ds_read_b32 v226, v226 offset:528
    ds_read_b32 v227, v227 offset:536
    ds_read_b32 v228, v228 offset:544
    ds_read_b32 v229, v229 offset:552
    ds_read_b32 v230, v230 offset:560
    ds_read_b32 v231, v231 offset:568
    s_setprio 2
    s_cmp_ge_u32 s26, 6
    s_cbranch_scc0 L_a_bar
    s_waitcnt vmcnt(1)
L_a_bar:
    s_waitcnt lgkmcnt(0)
    s_mov_b32 s3, 9
L_att_disp:
    s_cmp_eq_u32 s77, 1
    s_cbranch_scc1 L_att1
    s_cmp_eq_u32 s77, 2
    s_cbranch_scc1 L_att2
    s_cmp_eq_u32 s77, 3
    s_cbranch_scc1 L_att3
    s_cmp_eq_u32 s77, 4
    s_cbranch_scc1 L_att4
L_att0:
    s_cmp_eq_u32 s3, 9
    s_cbranch_scc0 L_attb0
    s_barrier
L_attb0:
    ds_read_b128 v[128:131], v198 offset:0
    ds_read_b128 v[132:135], v199 offset:0
    ds_read_b128 v[136:139], v198 offset:14336
    ds_read_b128 v[144:147], v198 offset:12288
    ds_read_b128 v[140:143], v199 offset:14336
    ds_read_b128 v[148:151], v199 offset:12288
    v_readfirstlane_b32 s78, v28
    v_mul_f32 v254, 0x3ea52b5c, v18
    v_readfirstlane_b32 s41, v29
    v_mov_b32 v56, v29
    v_mov_b32 v23, 0
    s_mov_b32 s63, 0
    s_waitcnt lgkmcnt(4)
    v_and_b32 v76, v128, v212
    v_and_b32 v77, v129, v212
    v_and_b32 v78, v130, v213
    v_and_b32 v79, v131, v213
    v_and_b32 v80, v132, v214
    v_and_b32 v81, v133, v214
    v_and_b32 v82, v134, v215
    v_and_b32 v83, v135, v215
    s_waitcnt lgkmcnt(0)
    v_mfma_f32_16x16x32_bf16 v[152:155], v[136:139], v[76:79], v[204:207]
    v_mfma_f32_16x16x32_bf16 v[156:159], v[144:147], v[76:79], v[208:211]
    v_mfma_f32_16x16x32_bf16 v[176:179], v[140:143], v[80:83], v[204:207]
    v_mfma_f32_16x16x32_bf16 v[180:183], v[148:151], v[80:83], v[208:211]
    v_and_b32 v84, v128, v216
    v_and_b32 v85, v129, v216
    v_and_b32 v86, v130, v217
    v_and_b32 v87, v131, v217
    v_and_b32 v96, v132, v222
    v_and_b32 v97, v133, v222
    v_and_b32 v98, v134, v223
    v_and_b32 v99, v135, v223
    v_max3_f32 v54, v176, v177, v180
    v_max3_f32 v55, v178, v179, v182
    v_max_f32 v54, v54, v181
    v_max_f32 v55, v55, v183
    s_cmp_eq_u32 s78, 1
    s_cbranch_scc0 L_xr_sx0
    buffer_store_dwordx3 v[54:56], v6, s[44:47], s5 offen
L_xd_sx0:
    v_mfma_f32_16x16x32_bf16 v[160:163], v[136:139], v[84:87], v[204:207]
    v_mfma_f32_16x16x32_bf16 v[164:167], v[144:147], v[84:87], v[208:211]
    v_mfma_f32_16x16x32_bf16 v[168:171], v[140:143], v[96:99], v[204:207]
    v_mfma_f32_16x16x32_bf16 v[172:175], v[148:151], v[96:99], v[208:211]
    v_and_b32 v88, v132, v218
    v_and_b32 v89, v133, v218
    v_and_b32 v90, v134, v219
    v_and_b32 v91, v135, v219
    s_nop 1
    v_mfma_f32_16x16x32_bf16 v[160:163], v[140:143], v[88:91], v[160:163]
    v_mfma_f32_16x16x32_bf16 v[164:167], v[148:151], v[88:91], v[164:167]
    buffer_load_dwordx3 v[112:114], v6, s[44:47], s15 offen offset:1024 sc1
    ds_read_b64_tr_b16 v[60:61], v200 offset:26624
    ds_read_b64_tr_b16 v[62:63], v200 offset:28672
    ds_read_b64_tr_b16 v[64:65], v201 offset:26624
    ds_read_b64_tr_b16 v[66:67], v201 offset:28672
    ds_read_b64_tr_b16 v[68:69], v202 offset:26624
    ds_read_b64_tr_b16 v[70:71], v202 offset:28672
    ds_read_b64_tr_b16 v[72:73], v203 offset:26624
    ds_read_b64_tr_b16 v[74:75], v203 offset:28672
    v_max3_f32 v48, v152, v153, v156
    v_max3_f32 v49, v154, v155, v158
    v_max_f32 v48, v48, v157
    v_max_f32 v49, v49, v159
    v_max3_f32 v52, v168, v169, v172
    v_max3_f32 v53, v170, v171, v174
    v_max_f32 v52, v52, v173
    v_max_f32 v53, v53, v175
    v_max3_f32 v50, v160, v161, v164
    v_max3_f32 v51, v162, v163, v166
    v_max_f32 v50, v50, v165
    v_max_f32 v51, v51, v167
L_sx_poll0:
    s_waitcnt vmcnt(0)
    v_cmp_ne_u32 vcc, s41, v114
    s_nop 0
    s_and_b64 s[60:61], vcc, s[6:7]
    s_cbranch_scc0 L_sx_ok0
    buffer_load_dwordx3 v[112:114], v6, s[44:47], s15 offen offset:1024 sc1
    s_add_u32 s63, s63, 1
    s_cmp_lt_u32 s63, 40000
    s_cbranch_scc1 L_sx_poll0
    s_waitcnt vmcnt(0)
L_sx_ok0:
    v_add_f32 v54, v54, v112
    v_add_f32 v55, v55, v113
    v_permlane32_swap_b32 v48, v52
    v_permlane32_swap_b32 v49, v53
    v_permlane32_swap_b32 v50, v54
    v_permlane32_swap_b32 v51, v55
    s_nop 0
    v_permlane16_swap_b32 v48, v50
    v_permlane16_swap_b32 v52, v54
    v_permlane16_swap_b32 v49, v51
    v_permlane16_swap_b32 v53, v55
    v_mul_f32 v48, v48, v224
    v_mul_f32 v49, v49, v225
    v_mul_f32 v50, v50, v226
    v_mul_f32 v51, v51, v227
    v_mul_f32 v52, v52, v228
    v_mul_f32 v53, v53, v229
    v_mul_f32 v54, v54, v230
    v_mul_f32 v55, v55, v231
    v_max3_f32 v252, v48, v49, v50
    v_max3_f32 v252, v252, v51, v52
    v_max3_f32 v252, v252, v53, v54
    v_max_f32 v252, v252, v55
    v_mul_f32 v252, v252, v254
    v_fma_f32 v48, v48, v254, -v252
    v_fma_f32 v49, v49, v254, -v252
    v_fma_f32 v50, v50, v254, -v252
    v_fma_f32 v51, v51, v254, -v252
    v_fma_f32 v52, v52, v254, -v252
    v_fma_f32 v53, v53, v254, -v252
    v_fma_f32 v54, v54, v254, -v252
    v_fma_f32 v55, v55, v254, -v252
    v_exp_f32 v48, v48
    v_exp_f32 v49, v49
    v_exp_f32 v50, v50
    v_exp_f32 v51, v51
    v_exp_f32 v52, v52
    v_exp_f32 v53, v53
    v_exp_f32 v54, v54
    v_exp_f32 v55, v55
    v_add_f32 v252, v48, v50
    v_add_f32 v253, v49, v51
    v_add_f32 v252, v252, v52
    v_add_f32 v253, v253, v53
    v_add_f32 v252, v252, v54
    v_add_f32 v253, v253, v55
    v_add_f32 v252, v252, v253
    v_rcp_f32 v252, v252
    v_mul_f32 v48, v48, v224
    v_mul_f32 v49, v49, v225
    v_mul_f32 v50, v50, v226
    v_mul_f32 v51, v51, v227
    v_mul_f32 v52, v52, v228
    v_mul_f32 v53, v53, v229
    v_mul_f32 v54, v54, v230
    v_mul_f32 v55, v55, v231
    v_mul_f32 v48, v48, v252
    v_mul_f32 v49, v49, v252
    v_mul_f32 v50, v50, v252
    v_mul_f32 v51, v51, v252
    v_mul_f32 v52, v52, v252
    v_mul_f32 v53, v53, v252
    v_mul_f32 v54, v54, v252
    v_mul_f32 v55, v55, v252
    v_cvt_pk_bf16_f32 v48, v48, v49
    v_cvt_pk_bf16_f32 v52, v52, v53
    v_cvt_pk_bf16_f32 v50, v50, v51
    v_cvt_pk_bf16_f32 v54, v54, v55
    v_permlane32_swap_b32 v48, v52
    s_waitcnt lgkmcnt(0)
    v_permlane32_swap_b32 v50, v54
    s_nop 1
    v_permlane16_swap_b32 v48, v50
    v_permlane16_swap_b32 v52, v54
    v_perm_b32 v236, v48, v48, v232
    v_perm_b32 v237, v48, v48, v233
    v_perm_b32 v238, v48, v48, v234
    v_perm_b32 v239, v48, v48, v235
    v_perm_b32 v240, v50, v50, v232
    v_perm_b32 v241, v50, v50, v233
    v_perm_b32 v242, v50, v50, v234
    v_perm_b32 v243, v50, v50, v235
    v_mfma_f32_16x16x32_bf16 v[76:79], v[60:63], v[236:239], 0
    v_mfma_f32_16x16x32_bf16 v[80:83], v[64:67], v[236:239], 0
    v_perm_b32 v244, v52, v52, v232
    v_perm_b32 v245, v52, v52, v233
    v_perm_b32 v246, v52, v52, v234
    v_perm_b32 v247, v52, v52, v235
    v_mfma_f32_16x16x32_bf16 v[84:87], v[64:67], v[240:243], 0
    v_mfma_f32_16x16x32_bf16 v[88:91], v[68:71], v[240:243], 0
    v_perm_b32 v248, v54, v54, v232
    v_perm_b32 v249, v54, v54, v233
    v_perm_b32 v250, v54, v54, v234
    v_perm_b32 v251, v54, v54, v235
    v_mfma_f32_16x16x32_bf16 v[92:95], v[68:71], v[244:247], 0
    v_mfma_f32_16x16x32_bf16 v[96:99], v[72:75], v[244:247], 0
    v_mfma_f32_16x16x32_bf16 v[100:103], v[72:75], v[248:251], 0
    buffer_load_dword v21, v16, s[44:47], s10 offen sc1
    v_cvt_pk_bf16_f32 v48, v76, v77
    v_cvt_pk_bf16_f32 v49, v78, v79
    v_cvt_pk_bf16_f32 v80, v80, v81
    v_cvt_pk_bf16_f32 v81, v82, v83
    v_cvt_pk_bf16_f32 v84, v84, v85
    v_cvt_pk_bf16_f32 v85, v86, v87
    v_cndmask_b32 v50, v80, v84, s[66:67]
    v_cndmask_b32 v51, v81, v85, s[66:67]
    v_cvt_pk_bf16_f32 v88, v88, v89
    v_cvt_pk_bf16_f32 v89, v90, v91
    v_cvt_pk_bf16_f32 v92, v92, v93
    v_cvt_pk_bf16_f32 v93, v94, v95
    v_cndmask_b32 v52, v88, v92, s[70:71]
    v_cndmask_b32 v53, v89, v93, s[70:71]
    v_cvt_pk_bf16_f32 v96, v96, v97
    v_cvt_pk_bf16_f32 v97, v98, v99
    v_cvt_pk_bf16_f32 v100, v100, v101
    v_cvt_pk_bf16_f32 v101, v102, v103
    v_cndmask_b32 v54, v96, v100, s[74:75]
    v_cndmask_b32 v55, v97, v101, s[74:75]
    s_cmp_eq_u32 s78, 1
    s_cbranch_scc0 L_xr_ox0
    buffer_store_dwordx4 v[48:51], v6, s[44:47], s15 offen
    buffer_store_dwordx4 v[52:55], v6, s[44:47], s15 offen offset:1024
L_xd_ox0:
    s_branch L_att_done
L_att1:
    s_cmp_eq_u32 s3, 9
    s_cbranch_scc0 L_attb1
    s_barrier
L_attb1:
    ds_read_b128 v[128:131], v198 offset:0
    ds_read_b128 v[132:135], v199 offset:0
    ds_read_b128 v[136:139], v198 offset:14336
    ds_read_b128 v[144:147], v198 offset:12288
    ds_read_b128 v[140:143], v199 offset:14336
    ds_read_b128 v[148:151], v199 offset:12288
    v_readfirstlane_b32 s78, v28
    v_mul_f32 v254, 0x3ea52b5c, v18
    v_readfirstlane_b32 s41, v29
    v_mov_b32 v50, v29
    v_mov_b32 v56, v29
    v_mov_b32 v23, 0
    s_mov_b32 s63, 0
    s_waitcnt lgkmcnt(4)
    v_and_b32 v76, v128, v212
    v_and_b32 v77, v129, v212
    v_and_b32 v78, v130, v213
    v_and_b32 v79, v131, v213
    v_and_b32 v80, v132, v214
    v_and_b32 v81, v133, v214
    v_and_b32 v82, v134, v215
    v_and_b32 v83, v135, v215
    s_waitcnt lgkmcnt(0)
    v_mfma_f32_16x16x32_bf16 v[152:155], v[136:139], v[76:79], v[204:207]
    v_mfma_f32_16x16x32_bf16 v[156:159], v[144:147], v[76:79], v[208:211]
    v_mfma_f32_16x16x32_bf16 v[176:179], v[140:143], v[80:83], v[204:207]
    v_mfma_f32_16x16x32_bf16 v[180:183], v[148:151], v[80:83], v[208:211]
    v_and_b32 v84, v128, v216
    v_and_b32 v85, v129, v216
    v_and_b32 v86, v130, v217
    v_and_b32 v87, v131, v217
    v_and_b32 v96, v132, v222
    v_and_b32 v97, v133, v222
    v_and_b32 v98, v134, v223
    v_and_b32 v99, v135, v223
    v_max3_f32 v48, v152, v153, v156
    v_max3_f32 v49, v154, v155, v158
    v_max_f32 v48, v48, v157
    v_max_f32 v49, v49, v159
    v_max3_f32 v54, v176, v177, v180
    v_max3_f32 v55, v178, v179, v182
    v_max_f32 v54, v54, v181
    v_max_f32 v55, v55, v183
    s_cmp_eq_u32 s78, 1
    s_cbranch_scc0 L_xr_sx1
    buffer_store_dwordx3 v[48:50], v6, s[44:47], s4 offen
    buffer_store_dwordx3 v[54:56], v6, s[44:47], s5 offen
L_xd_sx1:
    v_mfma_f32_16x16x32_bf16 v[160:163], v[136:139], v[84:87], v[204:207]
    v_mfma_f32_16x16x32_bf16 v[164:167], v[144:147], v[84:87], v[208:211]
    v_mfma_f32_16x16x32_bf16 v[168:171], v[140:143], v[96:99], v[204:207]
    v_mfma_f32_16x16x32_bf16 v[172:175], v[148:151], v[96:99], v[208:211]
    v_and_b32 v88, v132, v218
    v_and_b32 v89, v133, v218
    v_and_b32 v90, v134, v219
    v_and_b32 v91, v135, v219
    s_nop 1
    v_mfma_f32_16x16x32_bf16 v[160:163], v[140:143], v[88:91], v[160:163]
    v_mfma_f32_16x16x32_bf16 v[164:167], v[148:151], v[88:91], v[164:167]
    buffer_load_dwordx3 v[108:110], v6, s[44:47], s15 offen sc1
    buffer_load_dwordx3 v[112:114], v6, s[44:47], s15 offen offset:1024 sc1
    ds_read_b64_tr_b16 v[60:61], v200 offset:26624
    ds_read_b64_tr_b16 v[62:63], v200 offset:28672
    ds_read_b64_tr_b16 v[64:65], v201 offset:26624
    ds_read_b64_tr_b16 v[66:67], v201 offset:28672
    ds_read_b64_tr_b16 v[68:69], v202 offset:26624
    ds_read_b64_tr_b16 v[70:71], v202 offset:28672
    ds_read_b64_tr_b16 v[72:73], v203 offset:26624
    ds_read_b64_tr_b16 v[74:75], v203 offset:28672
    v_max3_f32 v52, v168, v169, v172
    v_max3_f32 v53, v170, v171, v174
    v_max_f32 v52, v52, v173
    v_max_f32 v53, v53, v175
    v_max3_f32 v50, v160, v161, v164
    v_max3_f32 v51, v162, v163, v166
    v_max_f32 v50, v50, v165
    v_max_f32 v51, v51, v167
L_sx_poll1:
    s_waitcnt vmcnt(0)
    v_cmp_ne_u32 vcc, s41, v110
    v_cmp_ne_u32 s[60:61], s41, v114
    s_nop 0
    s_or_b64 s[60:61], s[60:61], vcc
    s_and_b64 s[60:61], s[60:61], s[6:7]
    s_cbranch_scc0 L_sx_ok1
    buffer_load_dwordx3 v[108:110], v6, s[44:47], s15 offen sc1
    buffer_load_dwordx3 v[112:114], v6, s[44:47], s15 offen offset:1024 sc1
    s_add_u32 s63, s63, 1
    s_cmp_lt_u32 s63, 40000
    s_cbranch_scc1 L_sx_poll1
    s_waitcnt vmcnt(0)
L_sx_ok1:
    v_add_f32 v48, v48, v108
    v_add_f32 v49, v49, v109
    v_add_f32 v54, v54, v112
    v_add_f32 v55, v55, v113
    v_permlane32_swap_b32 v48, v52
    v_permlane32_swap_b32 v49, v53
    v_permlane32_swap_b32 v50, v54
    v_permlane32_swap_b32 v51, v55
    s_nop 0
    v_permlane16_swap_b32 v48, v50
    v_permlane16_swap_b32 v52, v54
    v_permlane16_swap_b32 v49, v51
    v_permlane16_swap_b32 v53, v55
    v_mul_f32 v48, v48, v224
    v_mul_f32 v49, v49, v225
    v_mul_f32 v50, v50, v226
    v_mul_f32 v51, v51, v227
    v_mul_f32 v52, v52, v228
    v_mul_f32 v53, v53, v229
    v_mul_f32 v54, v54, v230
    v_mul_f32 v55, v55, v231
    v_max3_f32 v252, v48, v49, v50
    v_max3_f32 v252, v252, v51, v52
    v_max3_f32 v252, v252, v53, v54
    v_max_f32 v252, v252, v55
    v_mul_f32 v252, v252, v254
    v_fma_f32 v48, v48, v254, -v252
    v_fma_f32 v49, v49, v254, -v252
    v_fma_f32 v50, v50, v254, -v252
    v_fma_f32 v51, v51, v254, -v252
    v_fma_f32 v52, v52, v254, -v252
    v_fma_f32 v53, v53, v254, -v252
    v_fma_f32 v54, v54, v254, -v252
    v_fma_f32 v55, v55, v254, -v252
    v_exp_f32 v48, v48
    v_exp_f32 v49, v49
    v_exp_f32 v50, v50
    v_exp_f32 v51, v51
    v_exp_f32 v52, v52
    v_exp_f32 v53, v53
    v_exp_f32 v54, v54
    v_exp_f32 v55, v55
    v_add_f32 v252, v48, v50
    v_add_f32 v253, v49, v51
    v_add_f32 v252, v252, v52
    v_add_f32 v253, v253, v53
    v_add_f32 v252, v252, v54
    v_add_f32 v253, v253, v55
    v_add_f32 v252, v252, v253
    v_rcp_f32 v252, v252
    v_mul_f32 v48, v48, v224
    v_mul_f32 v49, v49, v225
    v_mul_f32 v50, v50, v226
    v_mul_f32 v51, v51, v227
    v_mul_f32 v52, v52, v228
    v_mul_f32 v53, v53, v229
    v_mul_f32 v54, v54, v230
    v_mul_f32 v55, v55, v231
    v_mul_f32 v48, v48, v252
    v_mul_f32 v49, v49, v252
    v_mul_f32 v50, v50, v252
    v_mul_f32 v51, v51, v252
    v_mul_f32 v52, v52, v252
    v_mul_f32 v53, v53, v252
    v_mul_f32 v54, v54, v252
    v_mul_f32 v55, v55, v252
    v_cvt_pk_bf16_f32 v48, v48, v49
    v_cvt_pk_bf16_f32 v52, v52, v53
    v_cvt_pk_bf16_f32 v50, v50, v51
    v_cvt_pk_bf16_f32 v54, v54, v55
    v_permlane32_swap_b32 v48, v52
    s_waitcnt lgkmcnt(0)
    v_permlane32_swap_b32 v50, v54
    s_nop 1
    v_permlane16_swap_b32 v48, v50
    v_permlane16_swap_b32 v52, v54
    v_perm_b32 v236, v48, v48, v232
    v_perm_b32 v237, v48, v48, v233
    v_perm_b32 v238, v48, v48, v234
    v_perm_b32 v239, v48, v48, v235
    v_perm_b32 v240, v50, v50, v232
    v_perm_b32 v241, v50, v50, v233
    v_perm_b32 v242, v50, v50, v234
    v_perm_b32 v243, v50, v50, v235
    v_mfma_f32_16x16x32_bf16 v[76:79], v[60:63], v[236:239], 0
    v_perm_b32 v244, v52, v52, v232
    v_perm_b32 v245, v52, v52, v233
    v_perm_b32 v246, v52, v52, v234
    v_perm_b32 v247, v52, v52, v235
    v_mfma_f32_16x16x32_bf16 v[80:83], v[64:67], v[240:243], 0
    v_mfma_f32_16x16x32_bf16 v[84:87], v[68:71], v[240:243], 0
    v_perm_b32 v248, v54, v54, v232
    v_perm_b32 v249, v54, v54, v233
    v_perm_b32 v250, v54, v54, v234
    v_perm_b32 v251, v54, v54, v235
    v_mfma_f32_16x16x32_bf16 v[88:91], v[68:71], v[244:247], 0
    v_mfma_f32_16x16x32_bf16 v[92:95], v[72:75], v[244:247], 0
    v_mfma_f32_16x16x32_bf16 v[96:99], v[72:75], v[248:251], 0
    buffer_load_dword v21, v16, s[44:47], s10 offen sc1
    v_cvt_pk_bf16_f32 v48, v76, v77
    v_cvt_pk_bf16_f32 v49, v78, v79
    v_cvt_pk_bf16_f32 v50, v80, v81
    v_cvt_pk_bf16_f32 v51, v82, v83
    v_cvt_pk_bf16_f32 v84, v84, v85
    v_cvt_pk_bf16_f32 v85, v86, v87
    v_cvt_pk_bf16_f32 v88, v88, v89
    v_cvt_pk_bf16_f32 v89, v90, v91
    v_cndmask_b32 v52, v84, v88, s[70:71]
    v_cndmask_b32 v53, v85, v89, s[70:71]
    v_cvt_pk_bf16_f32 v92, v92, v93
    v_cvt_pk_bf16_f32 v93, v94, v95
    v_cvt_pk_bf16_f32 v96, v96, v97
    v_cvt_pk_bf16_f32 v97, v98, v99
    v_cndmask_b32 v54, v92, v96, s[74:75]
    v_cndmask_b32 v55, v93, v97, s[74:75]
    s_cmp_eq_u32 s78, 1
    s_cbranch_scc0 L_xr_ox1
    buffer_store_dwordx4 v[48:51], v6, s[44:47], s15 offen
    buffer_store_dwordx4 v[52:55], v6, s[44:47], s15 offen offset:1024
L_xd_ox1:
    s_branch L_att_done
L_att2:
    s_cmp_eq_u32 s3, 9
    s_cbranch_scc0 L_attb2
    s_barrier
L_attb2:
    ds_read_b128 v[128:131], v198 offset:0
    ds_read_b128 v[132:135], v199 offset:0
    ds_read_b128 v[136:139], v198 offset:14336
    ds_read_b128 v[144:147], v198 offset:12288
    ds_read_b128 v[140:143], v199 offset:14336
    ds_read_b128 v[148:151], v199 offset:12288
    v_readfirstlane_b32 s78, v28
    v_mul_f32 v254, 0x3ea52b5c, v18
    v_readfirstlane_b32 s41, v29
    v_mov_b32 v50, v29
    v_mov_b32 v56, v29
    v_mov_b32 v23, 0
    s_mov_b32 s63, 0
    s_waitcnt lgkmcnt(4)
    v_and_b32 v76, v128, v212
    v_and_b32 v77, v129, v212
    v_and_b32 v78, v130, v213
    v_and_b32 v79, v131, v213
    v_and_b32 v80, v132, v214
    v_and_b32 v81, v133, v214
    v_and_b32 v82, v134, v215
    v_and_b32 v83, v135, v215
    s_waitcnt lgkmcnt(0)
    v_mfma_f32_16x16x32_bf16 v[152:155], v[136:139], v[76:79], v[204:207]
    v_mfma_f32_16x16x32_bf16 v[156:159], v[144:147], v[76:79], v[208:211]
    v_mfma_f32_16x16x32_bf16 v[176:179], v[140:143], v[80:83], v[204:207]
    v_mfma_f32_16x16x32_bf16 v[180:183], v[148:151], v[80:83], v[208:211]
    v_and_b32 v84, v128, v216
    v_and_b32 v85, v129, v216
    v_and_b32 v86, v130, v217
    v_and_b32 v87, v131, v217
    v_and_b32 v96, v132, v222
    v_and_b32 v97, v133, v222
    v_and_b32 v98, v134, v223
    v_and_b32 v99, v135, v223
    v_max3_f32 v48, v152, v153, v156
    v_max3_f32 v49, v154, v155, v158
    v_max_f32 v48, v48, v157
    v_max_f32 v49, v49, v159
    v_max3_f32 v54, v176, v177, v180
    v_max3_f32 v55, v178, v179, v182
    v_max_f32 v54, v54, v181
    v_max_f32 v55, v55, v183
    s_cmp_eq_u32 s78, 1
    s_cbranch_scc0 L_xr_sx2
    buffer_store_dwordx3 v[48:50], v6, s[44:47], s4 offen
    buffer_store_dwordx3 v[54:56], v6, s[44:47], s5 offen
L_xd_sx2:
    v_mfma_f32_16x16x32_bf16 v[160:163], v[136:139], v[84:87], v[204:207]
    v_mfma_f32_16x16x32_bf16 v[164:167], v[144:147], v[84:87], v[208:211]
    v_mfma_f32_16x16x32_bf16 v[168:171], v[140:143], v[96:99], v[204:207]
    v_mfma_f32_16x16x32_bf16 v[172:175], v[148:151], v[96:99], v[208:211]
    buffer_load_dwordx3 v[108:110], v6, s[44:47], s15 offen sc1
    buffer_load_dwordx3 v[112:114], v6, s[44:47], s15 offen offset:1024 sc1
    ds_read_b64_tr_b16 v[60:61], v200 offset:26624
    ds_read_b64_tr_b16 v[62:63], v200 offset:28672
    ds_read_b64_tr_b16 v[64:65], v201 offset:26624
    ds_read_b64_tr_b16 v[66:67], v201 offset:28672
    ds_read_b64_tr_b16 v[68:69], v202 offset:26624
    ds_read_b64_tr_b16 v[70:71], v202 offset:28672
    ds_read_b64_tr_b16 v[72:73], v203 offset:26624
    ds_read_b64_tr_b16 v[74:75], v203 offset:28672
    v_max3_f32 v50, v160, v161, v164
    v_max3_f32 v51, v162, v163, v166
    v_max_f32 v50, v50, v165
    v_max_f32 v51, v51, v167
    v_max3_f32 v52, v168, v169, v172
    v_max3_f32 v53, v170, v171, v174
    v_max_f32 v52, v52, v173
    v_max_f32 v53, v53, v175
L_sx_poll2:
    s_waitcnt vmcnt(0)
    v_cmp_ne_u32 vcc, s41, v110
    v_cmp_ne_u32 s[60:61], s41, v114
    s_nop 0
    s_or_b64 s[60:61], s[60:61], vcc
    s_and_b64 s[60:61], s[60:61], s[6:7]
    s_cbranch_scc0 L_sx_ok2
    buffer_load_dwordx3 v[108:110], v6, s[44:47], s15 offen sc1
    buffer_load_dwordx3 v[112:114], v6, s[44:47], s15 offen offset:1024 sc1
    s_add_u32 s63, s63, 1
    s_cmp_lt_u32 s63, 40000
    s_cbranch_scc1 L_sx_poll2
    s_waitcnt vmcnt(0)
L_sx_ok2:
    v_add_f32 v48, v48, v108
    v_add_f32 v49, v49, v109
    v_add_f32 v54, v54, v112
    v_add_f32 v55, v55, v113
    v_permlane32_swap_b32 v48, v52
    v_permlane32_swap_b32 v49, v53
    v_permlane32_swap_b32 v50, v54
    v_permlane32_swap_b32 v51, v55
    s_nop 0
    v_permlane16_swap_b32 v48, v50
    v_permlane16_swap_b32 v52, v54
    v_permlane16_swap_b32 v49, v51
    v_permlane16_swap_b32 v53, v55
    v_mul_f32 v48, v48, v224
    v_mul_f32 v49, v49, v225
    v_mul_f32 v50, v50, v226
    v_mul_f32 v51, v51, v227
    v_mul_f32 v52, v52, v228
    v_mul_f32 v53, v53, v229
    v_mul_f32 v54, v54, v230
    v_mul_f32 v55, v55, v231
    v_max3_f32 v252, v48, v49, v50
    v_max3_f32 v252, v252, v51, v52
    v_max3_f32 v252, v252, v53, v54
    v_max_f32 v252, v252, v55
    v_mul_f32 v252, v252, v254
    v_fma_f32 v48, v48, v254, -v252
    v_fma_f32 v49, v49, v254, -v252
    v_fma_f32 v50, v50, v254, -v252
    v_fma_f32 v51, v51, v254, -v252
    v_fma_f32 v52, v52, v254, -v252
    v_fma_f32 v53, v53, v254, -v252
    v_fma_f32 v54, v54, v254, -v252
    v_fma_f32 v55, v55, v254, -v252
    v_exp_f32 v48, v48
    v_exp_f32 v49, v49
    v_exp_f32 v50, v50
    v_exp_f32 v51, v51
    v_exp_f32 v52, v52
    v_exp_f32 v53, v53
    v_exp_f32 v54, v54
    v_exp_f32 v55, v55
    v_add_f32 v252, v48, v50
    v_add_f32 v253, v49, v51
    v_add_f32 v252, v252, v52
    v_add_f32 v253, v253, v53
    v_add_f32 v252, v252, v54
    v_add_f32 v253, v253, v55
    v_add_f32 v252, v252, v253
    v_rcp_f32 v252, v252
    v_mul_f32 v48, v48, v224
    v_mul_f32 v49, v49, v225
    v_mul_f32 v50, v50, v226
    v_mul_f32 v51, v51, v227
    v_mul_f32 v52, v52, v228
    v_mul_f32 v53, v53, v229
    v_mul_f32 v54, v54, v230
    v_mul_f32 v55, v55, v231
    v_mul_f32 v48, v48, v252
    v_mul_f32 v49, v49, v252
    v_mul_f32 v50, v50, v252
    v_mul_f32 v51, v51, v252
    v_mul_f32 v52, v52, v252
    v_mul_f32 v53, v53, v252
    v_mul_f32 v54, v54, v252
    v_mul_f32 v55, v55, v252
    v_cvt_pk_bf16_f32 v48, v48, v49
    v_cvt_pk_bf16_f32 v52, v52, v53
    v_cvt_pk_bf16_f32 v50, v50, v51
    v_cvt_pk_bf16_f32 v54, v54, v55
    v_permlane32_swap_b32 v48, v52
    s_waitcnt lgkmcnt(0)
    v_permlane32_swap_b32 v50, v54
    s_nop 1
    v_permlane16_swap_b32 v48, v50
    v_permlane16_swap_b32 v52, v54
    v_perm_b32 v236, v48, v48, v232
    v_perm_b32 v237, v48, v48, v233
    v_perm_b32 v238, v48, v48, v234
    v_perm_b32 v239, v48, v48, v235
    v_perm_b32 v240, v50, v50, v232
    v_perm_b32 v241, v50, v50, v233
    v_perm_b32 v242, v50, v50, v234
    v_perm_b32 v243, v50, v50, v235
    v_mfma_f32_16x16x32_bf16 v[76:79], v[60:63], v[236:239], 0
    v_perm_b32 v244, v52, v52, v232
    v_perm_b32 v245, v52, v52, v233
    v_perm_b32 v246, v52, v52, v234
    v_perm_b32 v247, v52, v52, v235
    v_mfma_f32_16x16x32_bf16 v[80:83], v[60:63], v[240:243], 0
    v_mfma_f32_16x16x32_bf16 v[84:87], v[64:67], v[240:243], 0
    v_perm_b32 v248, v54, v54, v232
    v_perm_b32 v249, v54, v54, v233
    v_perm_b32 v250, v54, v54, v234
    v_perm_b32 v251, v54, v54, v235
    v_mfma_f32_16x16x32_bf16 v[88:91], v[68:71], v[244:247], 0
    v_mfma_f32_16x16x32_bf16 v[92:95], v[72:75], v[244:247], 0
    v_mfma_f32_16x16x32_bf16 v[96:99], v[72:75], v[248:251], 0
    buffer_load_dword v21, v16, s[44:47], s10 offen sc1
    v_cvt_pk_bf16_f32 v76, v76, v77
    v_cvt_pk_bf16_f32 v77, v78, v79
    v_cvt_pk_bf16_f32 v80, v80, v81
    v_cvt_pk_bf16_f32 v81, v82, v83
    v_cndmask_b32 v48, v76, v80, s[64:65]
    v_cndmask_b32 v49, v77, v81, s[64:65]
    v_cvt_pk_bf16_f32 v50, v84, v85
    v_cvt_pk_bf16_f32 v51, v86, v87
    v_cvt_pk_bf16_f32 v52, v88, v89
    v_cvt_pk_bf16_f32 v53, v90, v91
    v_cvt_pk_bf16_f32 v92, v92, v93
    v_cvt_pk_bf16_f32 v93, v94, v95
    v_cvt_pk_bf16_f32 v96, v96, v97
    v_cvt_pk_bf16_f32 v97, v98, v99
    v_cndmask_b32 v54, v92, v96, s[74:75]
    v_cndmask_b32 v55, v93, v97, s[74:75]
    s_cmp_eq_u32 s78, 1
    s_cbranch_scc0 L_xr_ox2
    buffer_store_dwordx4 v[48:51], v6, s[44:47], s15 offen
    buffer_store_dwordx4 v[52:55], v6, s[44:47], s15 offen offset:1024
L_xd_ox2:
    s_branch L_att_done
L_att3:
    s_cmp_eq_u32 s3, 9
    s_cbranch_scc0 L_attb3
    s_barrier
L_attb3:
    ds_read_b128 v[128:131], v198 offset:0
    ds_read_b128 v[132:135], v199 offset:0
    ds_read_b128 v[136:139], v198 offset:14336
    ds_read_b128 v[144:147], v198 offset:12288
    ds_read_b128 v[140:143], v199 offset:14336
    ds_read_b128 v[148:151], v199 offset:12288
    v_readfirstlane_b32 s78, v28
    v_mul_f32 v254, 0x3ea52b5c, v18
    v_readfirstlane_b32 s41, v29
    v_mov_b32 v50, v29
    v_mov_b32 v56, v29
    v_mov_b32 v23, 0
    s_mov_b32 s63, 0
    s_waitcnt lgkmcnt(4)
    v_and_b32 v76, v128, v212
    v_and_b32 v77, v129, v212
    v_and_b32 v78, v130, v213
    v_and_b32 v79, v131, v213
    v_and_b32 v80, v132, v214
    v_and_b32 v81, v133, v214
    v_and_b32 v82, v134, v215
    v_and_b32 v83, v135, v215
    s_waitcnt lgkmcnt(0)
    v_mfma_f32_16x16x32_bf16 v[152:155], v[136:139], v[76:79], v[204:207]
    v_mfma_f32_16x16x32_bf16 v[156:159], v[144:147], v[76:79], v[208:211]
    v_mfma_f32_16x16x32_bf16 v[176:179], v[140:143], v[80:83], v[204:207]
    v_mfma_f32_16x16x32_bf16 v[180:183], v[148:151], v[80:83], v[208:211]
    v_and_b32 v84, v128, v216
    v_and_b32 v85, v129, v216
    v_and_b32 v86, v130, v217
    v_and_b32 v87, v131, v217
    v_and_b32 v96, v132, v222
    v_and_b32 v97, v133, v222
    v_and_b32 v98, v134, v223
    v_and_b32 v99, v135, v223
    v_max3_f32 v48, v152, v153, v156
    v_max3_f32 v49, v154, v155, v158
    v_max_f32 v48, v48, v157
    v_max_f32 v49, v49, v159
    v_max3_f32 v54, v176, v177, v180
    v_max3_f32 v55, v178, v179, v182
    v_max_f32 v54, v54, v181
    v_max_f32 v55, v55, v183
    s_cmp_eq_u32 s78, 1
    s_cbranch_scc0 L_xr_sx3
    buffer_store_dwordx3 v[48:50], v6, s[44:47], s4 offen
    buffer_store_dwordx3 v[54:56], v6, s[44:47], s5 offen
L_xd_sx3:
    v_mfma_f32_16x16x32_bf16 v[160:163], v[136:139], v[84:87], v[204:207]
    v_mfma_f32_16x16x32_bf16 v[164:167], v[144:147], v[84:87], v[208:211]
    v_mfma_f32_16x16x32_bf16 v[168:171], v[140:143], v[96:99], v[204:207]
    v_mfma_f32_16x16x32_bf16 v[172:175], v[148:151], v[96:99], v[208:211]
    v_and_b32 v92, v128, v220
    v_and_b32 v93, v129, v220
    v_and_b32 v94, v130, v221
    v_and_b32 v95, v131, v221
    s_nop 1
    v_mfma_f32_16x16x32_bf16 v[168:171], v[136:139], v[92:95], v[168:171]
    v_mfma_f32_16x16x32_bf16 v[172:175], v[144:147], v[92:95], v[172:175]
    buffer_load_dwordx3 v[108:110], v6, s[44:47], s15 offen sc1
    buffer_load_dwordx3 v[112:114], v6, s[44:47], s15 offen offset:1024 sc1
    ds_read_b64_tr_b16 v[60:61], v200 offset:26624
    ds_read_b64_tr_b16 v[62:63], v200 offset:28672
    ds_read_b64_tr_b16 v[64:65], v201 offset:26624
    ds_read_b64_tr_b16 v[66:67], v201 offset:28672
    ds_read_b64_tr_b16 v[68:69], v202 offset:26624
    ds_read_b64_tr_b16 v[70:71], v202 offset:28672
    ds_read_b64_tr_b16 v[72:73], v203 offset:26624
    ds_read_b64_tr_b16 v[74:75], v203 offset:28672
    v_max3_f32 v50, v160, v161, v164
    v_max3_f32 v51, v162, v163, v166
    v_max_f32 v50, v50, v165
    v_max_f32 v51, v51, v167
    v_max3_f32 v52, v168, v169, v172
    v_max3_f32 v53, v170, v171, v174
    v_max_f32 v52, v52, v173
    v_max_f32 v53, v53, v175
L_sx_poll3:
    s_waitcnt vmcnt(0)
    v_cmp_ne_u32 vcc, s41, v110
    v_cmp_ne_u32 s[60:61], s41, v114
    s_nop 0
    s_or_b64 s[60:61], s[60:61], vcc
    s_and_b64 s[60:61], s[60:61], s[6:7]
    s_cbranch_scc0 L_sx_ok3
    buffer_load_dwordx3 v[108:110], v6, s[44:47], s15 offen sc1
    buffer_load_dwordx3 v[112:114], v6, s[44:47], s15 offen offset:1024 sc1
    s_add_u32 s63, s63, 1
    s_cmp_lt_u32 s63, 40000
    s_cbranch_scc1 L_sx_poll3
    s_waitcnt vmcnt(0)
L_sx_ok3:
    v_add_f32 v48, v48, v108
    v_add_f32 v49, v49, v109
    v_add_f32 v54, v54, v112
    v_add_f32 v55, v55, v113
    v_permlane32_swap_b32 v48, v52
    v_permlane32_swap_b32 v49, v53
    v_permlane32_swap_b32 v50, v54
    v_permlane32_swap_b32 v51, v55
    s_nop 0
    v_permlane16_swap_b32 v48, v50
    v_permlane16_swap_b32 v52, v54
    v_permlane16_swap_b32 v49, v51
    v_permlane16_swap_b32 v53, v55
    v_mul_f32 v48, v48, v224
    v_mul_f32 v49, v49, v225
    v_mul_f32 v50, v50, v226
    v_mul_f32 v51, v51, v227
    v_mul_f32 v52, v52, v228
    v_mul_f32 v53, v53, v229
    v_mul_f32 v54, v54, v230
    v_mul_f32 v55, v55, v231
    v_max3_f32 v252, v48, v49, v50
    v_max3_f32 v252, v252, v51, v52
    v_max3_f32 v252, v252, v53, v54
    v_max_f32 v252, v252, v55
    v_mul_f32 v252, v252, v254
    v_fma_f32 v48, v48, v254, -v252
    v_fma_f32 v49, v49, v254, -v252
    v_fma_f32 v50, v50, v254, -v252
    v_fma_f32 v51, v51, v254, -v252
    v_fma_f32 v52, v52, v254, -v252
    v_fma_f32 v53, v53, v254, -v252
    v_fma_f32 v54, v54, v254, -v252
    v_fma_f32 v55, v55, v254, -v252
    v_exp_f32 v48, v48
    v_exp_f32 v49, v49
    v_exp_f32 v50, v50
    v_exp_f32 v51, v51
    v_exp_f32 v52, v52
    v_exp_f32 v53, v53
    v_exp_f32 v54, v54
    v_exp_f32 v55, v55
    v_add_f32 v252, v48, v50
    v_add_f32 v253, v49, v51
    v_add_f32 v252, v252, v52
    v_add_f32 v253, v253, v53
    v_add_f32 v252, v252, v54
    v_add_f32 v253, v253, v55
    v_add_f32 v252, v252, v253
    v_rcp_f32 v252, v252
    v_mul_f32 v48, v48, v224
    v_mul_f32 v49, v49, v225
    v_mul_f32 v50, v50, v226
    v_mul_f32 v51, v51, v227
    v_mul_f32 v52, v52, v228
    v_mul_f32 v53, v53, v229
    v_mul_f32 v54, v54, v230
    v_mul_f32 v55, v55, v231
    v_mul_f32 v48, v48, v252
    v_mul_f32 v49, v49, v252
    v_mul_f32 v50, v50, v252
    v_mul_f32 v51, v51, v252
    v_mul_f32 v52, v52, v252
    v_mul_f32 v53, v53, v252
    v_mul_f32 v54, v54, v252
    v_mul_f32 v55, v55, v252
    v_cvt_pk_bf16_f32 v48, v48, v49
    v_cvt_pk_bf16_f32 v52, v52, v53
    v_cvt_pk_bf16_f32 v50, v50, v51
    v_cvt_pk_bf16_f32 v54, v54, v55
    v_permlane32_swap_b32 v48, v52
    s_waitcnt lgkmcnt(0)
    v_permlane32_swap_b32 v50, v54
    s_nop 1
    v_permlane16_swap_b32 v48, v50
    v_permlane16_swap_b32 v52, v54
    v_perm_b32 v236, v48, v48, v232
    v_perm_b32 v237, v48, v48, v233
    v_perm_b32 v238, v48, v48, v234
    v_perm_b32 v239, v48, v48, v235
    v_perm_b32 v240, v50, v50, v232
    v_perm_b32 v241, v50, v50, v233
    v_perm_b32 v242, v50, v50, v234
    v_perm_b32 v243, v50, v50, v235
    v_mfma_f32_16x16x32_bf16 v[76:79], v[60:63], v[236:239], 0
    v_perm_b32 v244, v52, v52, v232
    v_perm_b32 v245, v52, v52, v233
    v_perm_b32 v246, v52, v52, v234
    v_perm_b32 v247, v52, v52, v235
    v_mfma_f32_16x16x32_bf16 v[80:83], v[60:63], v[240:243], 0
    v_mfma_f32_16x16x32_bf16 v[84:87], v[64:67], v[240:243], 0
    v_perm_b32 v248, v54, v54, v232
    v_perm_b32 v249, v54, v54, v233
    v_perm_b32 v250, v54, v54, v234
    v_perm_b32 v251, v54, v54, v235
    v_mfma_f32_16x16x32_bf16 v[88:91], v[64:67], v[244:247], 0
    v_mfma_f32_16x16x32_bf16 v[92:95], v[68:71], v[244:247], 0
    v_mfma_f32_16x16x32_bf16 v[96:99], v[72:75], v[248:251], 0
    buffer_load_dword v21, v16, s[44:47], s10 offen sc1
    v_cvt_pk_bf16_f32 v76, v76, v77
    v_cvt_pk_bf16_f32 v77, v78, v79
    v_cvt_pk_bf16_f32 v80, v80, v81
    v_cvt_pk_bf16_f32 v81, v82, v83
    v_cndmask_b32 v48, v76, v80, s[64:65]
    v_cndmask_b32 v49, v77, v81, s[64:65]
    v_cvt_pk_bf16_f32 v84, v84, v85
    v_cvt_pk_bf16_f32 v85, v86, v87
    v_cvt_pk_bf16_f32 v88, v88, v89
    v_cvt_pk_bf16_f32 v89, v90, v91
    v_cndmask_b32 v50, v84, v88, s[68:69]
    v_cndmask_b32 v51, v85, v89, s[68:69]
    v_cvt_pk_bf16_f32 v52, v92, v93
    v_cvt_pk_bf16_f32 v53, v94, v95
    v_cvt_pk_bf16_f32 v54, v96, v97
    v_cvt_pk_bf16_f32 v55, v98, v99
    s_cmp_eq_u32 s78, 1
    s_cbranch_scc0 L_xr_ox3
    buffer_store_dwordx4 v[48:51], v6, s[44:47], s15 offen
    buffer_store_dwordx4 v[52:55], v6, s[44:47], s15 offen offset:1024
L_xd_ox3:
    s_branch L_att_done
L_att4:
    s_cmp_eq_u32 s3, 9
    s_cbranch_scc0 L_attb4
    s_barrier
L_attb4:
    ds_read_b128 v[128:131], v198 offset:0
    ds_read_b128 v[132:135], v199 offset:0
    ds_read_b128 v[136:139], v198 offset:14336
    ds_read_b128 v[144:147], v198 offset:12288
    ds_read_b128 v[140:143], v199 offset:14336
    ds_read_b128 v[148:151], v199 offset:12288
    v_readfirstlane_b32 s78, v28
    v_mul_f32 v254, 0x3ea52b5c, v18
    v_readfirstlane_b32 s41, v29
    v_mov_b32 v50, v29
    v_mov_b32 v23, 0
    s_mov_b32 s63, 0
    s_waitcnt lgkmcnt(4)
    v_and_b32 v76, v128, v212
    v_and_b32 v77, v129, v212
    v_and_b32 v78, v130, v213
    v_and_b32 v79, v131, v213
    v_and_b32 v80, v132, v214
    v_and_b32 v81, v133, v214
    v_and_b32 v82, v134, v215
    v_and_b32 v83, v135, v215
    s_waitcnt lgkmcnt(0)
    v_mfma_f32_16x16x32_bf16 v[152:155], v[136:139], v[76:79], v[204:207]
    v_mfma_f32_16x16x32_bf16 v[156:159], v[144:147], v[76:79], v[208:211]
    v_mfma_f32_16x16x32_bf16 v[176:179], v[140:143], v[80:83], v[204:207]
    v_mfma_f32_16x16x32_bf16 v[180:183], v[148:151], v[80:83], v[208:211]
    v_and_b32 v84, v128, v216
    v_and_b32 v85, v129, v216
    v_and_b32 v86, v130, v217
    v_and_b32 v87, v131, v217
    v_and_b32 v96, v132, v222
    v_and_b32 v97, v133, v222
    v_and_b32 v98, v134, v223
    v_and_b32 v99, v135, v223
    v_max3_f32 v48, v152, v153, v156
    v_max3_f32 v49, v154, v155, v158
    v_max_f32 v48, v48, v157
    v_max_f32 v49, v49, v159
    s_cmp_eq_u32 s78, 1
    s_cbranch_scc0 L_xr_sx4
    buffer_store_dwordx3 v[48:50], v6, s[44:47], s4 offen
L_xd_sx4:
    v_mfma_f32_16x16x32_bf16 v[160:163], v[136:139], v[84:87], v[204:207]
    v_mfma_f32_16x16x32_bf16 v[164:167], v[144:147], v[84:87], v[208:211]
    v_mfma_f32_16x16x32_bf16 v[168:171], v[140:143], v[96:99], v[204:207]
    v_mfma_f32_16x16x32_bf16 v[172:175], v[148:151], v[96:99], v[208:211]
    v_and_b32 v92, v128, v220
    v_and_b32 v93, v129, v220
    v_and_b32 v94, v130, v221
    v_and_b32 v95, v131, v221
    s_nop 1
    v_mfma_f32_16x16x32_bf16 v[168:171], v[136:139], v[92:95], v[168:171]
    v_mfma_f32_16x16x32_bf16 v[172:175], v[144:147], v[92:95], v[172:175]
    buffer_load_dwordx3 v[108:110], v6, s[44:47], s15 offen sc1
    ds_read_b64_tr_b16 v[60:61], v200 offset:26624
    ds_read_b64_tr_b16 v[62:63], v200 offset:28672
    ds_read_b64_tr_b16 v[64:65], v201 offset:26624
    ds_read_b64_tr_b16 v[66:67], v201 offset:28672
    ds_read_b64_tr_b16 v[68:69], v202 offset:26624
    ds_read_b64_tr_b16 v[70:71], v202 offset:28672
    ds_read_b64_tr_b16 v[72:73], v203 offset:26624
    ds_read_b64_tr_b16 v[74:75], v203 offset:28672
    v_max3_f32 v54, v176, v177, v180
    v_max3_f32 v55, v178, v179, v182
    v_max_f32 v54, v54, v181
    v_max_f32 v55, v55, v183
    v_max3_f32 v50, v160, v161, v164
    v_max3_f32 v51, v162, v163, v166
    v_max_f32 v50, v50, v165
    v_max_f32 v51, v51, v167
    v_max3_f32 v52, v168, v169, v172
    v_max3_f32 v53, v170, v171, v174
    v_max_f32 v52, v52, v173
    v_max_f32 v53, v53, v175
L_sx_poll4:
    s_waitcnt vmcnt(0)
    v_cmp_ne_u32 vcc, s41, v110
    s_nop 0
    s_and_b64 s[60:61], vcc, s[6:7]
    s_cbranch_scc0 L_sx_ok4
    buffer_load_dwordx3 v[108:110], v6, s[44:47], s15 offen sc1
    s_add_u32 s63, s63, 1
    s_cmp_lt_u32 s63, 40000
    s_cbranch_scc1 L_sx_poll4
    s_waitcnt vmcnt(0)
L_sx_ok4:
    v_add_f32 v48, v48, v108
    v_add_f32 v49, v49, v109
    v_permlane32_swap_b32 v50, v54
    v_permlane32_swap_b32 v51, v55
    v_permlane32_swap_b32 v48, v52
    v_permlane32_swap_b32 v49, v53
    s_nop 0
    v_permlane16_swap_b32 v48, v50
    v_permlane16_swap_b32 v52, v54
    v_permlane16_swap_b32 v49, v51
    v_permlane16_swap_b32 v53, v55
    v_mul_f32 v48, v48, v224
    v_mul_f32 v49, v49, v225
    v_mul_f32 v50, v50, v226
    v_mul_f32 v51, v51, v227
    v_mul_f32 v52, v52, v228
    v_mul_f32 v53, v53, v229
    v_mul_f32 v54, v54, v230
    v_mul_f32 v55, v55, v231
    v_max3_f32 v252, v48, v49, v50
    v_max3_f32 v252, v252, v51, v52
    v_max3_f32 v252, v252, v53, v54
    v_max_f32 v252, v252, v55
    v_mul_f32 v252, v252, v254
    v_fma_f32 v48, v48, v254, -v252
    v_fma_f32 v49, v49, v254, -v252
    v_fma_f32 v50, v50, v254, -v252
    v_fma_f32 v51, v51, v254, -v252
    v_fma_f32 v52, v52, v254, -v252
    v_fma_f32 v53, v53, v254, -v252
    v_fma_f32 v54, v54, v254, -v252
    v_fma_f32 v55, v55, v254, -v252
    v_exp_f32 v48, v48
    v_exp_f32 v49, v49
    v_exp_f32 v50, v50
    v_exp_f32 v51, v51
    v_exp_f32 v52, v52
    v_exp_f32 v53, v53
    v_exp_f32 v54, v54
    v_exp_f32 v55, v55
    v_add_f32 v252, v48, v50
    v_add_f32 v253, v49, v51
    v_add_f32 v252, v252, v52
    v_add_f32 v253, v253, v53
    v_add_f32 v252, v252, v54
    v_add_f32 v253, v253, v55
    v_add_f32 v252, v252, v253
    v_rcp_f32 v252, v252
    v_mul_f32 v48, v48, v224
    v_mul_f32 v49, v49, v225
    v_mul_f32 v50, v50, v226
    v_mul_f32 v51, v51, v227
    v_mul_f32 v52, v52, v228
    v_mul_f32 v53, v53, v229
    v_mul_f32 v54, v54, v230
    v_mul_f32 v55, v55, v231
    v_mul_f32 v48, v48, v252
    v_mul_f32 v49, v49, v252
    v_mul_f32 v50, v50, v252
    v_mul_f32 v51, v51, v252
    v_mul_f32 v52, v52, v252
    v_mul_f32 v53, v53, v252
    v_mul_f32 v54, v54, v252
    v_mul_f32 v55, v55, v252
    v_cvt_pk_bf16_f32 v48, v48, v49
    v_cvt_pk_bf16_f32 v52, v52, v53
    v_cvt_pk_bf16_f32 v50, v50, v51
    v_cvt_pk_bf16_f32 v54, v54, v55
    v_permlane32_swap_b32 v48, v52
    s_waitcnt lgkmcnt(0)
    v_permlane32_swap_b32 v50, v54
    s_nop 1
    v_permlane16_swap_b32 v48, v50
    v_permlane16_swap_b32 v52, v54
    v_perm_b32 v236, v48, v48, v232
    v_perm_b32 v237, v48, v48, v233
    v_perm_b32 v238, v48, v48, v234
    v_perm_b32 v239, v48, v48, v235
    v_perm_b32 v240, v50, v50, v232
    v_perm_b32 v241, v50, v50, v233
    v_perm_b32 v242, v50, v50, v234
    v_perm_b32 v243, v50, v50, v235
    v_mfma_f32_16x16x32_bf16 v[76:79], v[60:63], v[236:239], 0
    v_perm_b32 v244, v52, v52, v232
    v_perm_b32 v245, v52, v52, v233
    v_perm_b32 v246, v52, v52, v234
    v_perm_b32 v247, v52, v52, v235
    v_mfma_f32_16x16x32_bf16 v[80:83], v[60:63], v[240:243], 0
    v_mfma_f32_16x16x32_bf16 v[84:87], v[64:67], v[240:243], 0
    v_perm_b32 v248, v54, v54, v232
    v_perm_b32 v249, v54, v54, v233
    v_perm_b32 v250, v54, v54, v234
    v_perm_b32 v251, v54, v54, v235
    v_mfma_f32_16x16x32_bf16 v[88:91], v[64:67], v[244:247], 0
    v_mfma_f32_16x16x32_bf16 v[92:95], v[68:71], v[244:247], 0
    v_mfma_f32_16x16x32_bf16 v[96:99], v[68:71], v[248:251], 0
    v_mfma_f32_16x16x32_bf16 v[100:103], v[72:75], v[248:251], 0
    buffer_load_dword v21, v16, s[44:47], s10 offen sc1
    v_cvt_pk_bf16_f32 v76, v76, v77
    v_cvt_pk_bf16_f32 v77, v78, v79
    v_cvt_pk_bf16_f32 v80, v80, v81
    v_cvt_pk_bf16_f32 v81, v82, v83
    v_cndmask_b32 v48, v76, v80, s[64:65]
    v_cndmask_b32 v49, v77, v81, s[64:65]
    v_cvt_pk_bf16_f32 v84, v84, v85
    v_cvt_pk_bf16_f32 v85, v86, v87
    v_cvt_pk_bf16_f32 v88, v88, v89
    v_cvt_pk_bf16_f32 v89, v90, v91
    v_cndmask_b32 v50, v84, v88, s[68:69]
    v_cndmask_b32 v51, v85, v89, s[68:69]
    v_cvt_pk_bf16_f32 v92, v92, v93
    v_cvt_pk_bf16_f32 v93, v94, v95
    v_cvt_pk_bf16_f32 v96, v96, v97
    v_cvt_pk_bf16_f32 v97, v98, v99
    v_cndmask_b32 v52, v92, v96, s[72:73]
    v_cndmask_b32 v53, v93, v97, s[72:73]
    v_cvt_pk_bf16_f32 v54, v100, v101
    v_cvt_pk_bf16_f32 v55, v102, v103
    s_cmp_eq_u32 s78, 1
    s_cbranch_scc0 L_xr_ox4
    buffer_store_dwordx4 v[48:51], v6, s[44:47], s15 offen
    buffer_store_dwordx4 v[52:55], v6, s[44:47], s15 offen offset:1024
L_xd_ox4:
L_att_done:
    ds_read_b128 v[120:123], v11
    ds_read_b128 v[124:127], v11 offset:512
    ds_read_b64 v[112:113], v9 offset:24576
    ds_read_b64 v[114:115], v9 offset:24704
    ds_read_b64 v[116:117], v10 offset:24832
    ds_read_b64 v[118:119], v10 offset:24960
    ds_read_b128 v[128:131], v4 offset:0
    ds_read_b128 v[132:135], v4 offset:1024
    ds_read_b128 v[136:139], v4 offset:2048
    ds_read_b128 v[140:143], v4 offset:3072
    ds_read_b128 v[144:147], v4 offset:4096
    ds_read_b128 v[148:151], v4 offset:5120
    ds_read_b128 v[152:155], v4 offset:6144
    ds_read_b128 v[156:159], v4 offset:7168
    s_waitcnt vmcnt(0)
    s_mov_b64 exec, 1
    s_cmp_eq_u32 s78, 1
    s_cbranch_scc0 L_xr_fl
    buffer_store_dword v29, v23, s[44:47], s11 offen
L_xd_fl:
    s_mov_b64 exec, -1
    s_setprio 0
    v_cmp_eq_u32 vcc, s41, v21
    s_mov_b32 s42, 0
    s_and_b32 s58, vcc_lo, s43
    s_cmp_eq_u32 s58, s43
    s_cbranch_scc0 L_fl_n
    s_mov_b32 s42, 1
    buffer_load_dwordx4 v[56:59], v6, s[44:47], s32 offen offset:0 sc1
    buffer_load_dwordx4 v[60:63], v6, s[44:47], s32 offen offset:1024 sc1
    buffer_load_dwordx4 v[64:67], v6, s[44:47], s33 offen offset:0 sc1
    buffer_load_dwordx4 v[68:71], v6, s[44:47], s33 offen offset:1024 sc1
L_fl_n:
    s_waitcnt lgkmcnt(8)
    v_mul_f32 v120, v120, v124
    v_add_f32 v124, 1.0, v124
    v_lshlrev_b32 v32, 16, v112
    v_and_b32 v36, 0xffff0000, v112
    v_lshlrev_b32 v40, 16, v113
    v_and_b32 v44, 0xffff0000, v113
    v_fma_f32 v32, v32, v124, v120
    v_fma_f32 v36, v36, v124, v120
    v_fma_f32 v40, v40, v124, v120
    v_fma_f32 v44, v44, v124, v120
    v_mul_f32 v121, v121, v125
    v_add_f32 v125, 1.0, v125
    v_lshlrev_b32 v33, 16, v114
    v_and_b32 v37, 0xffff0000, v114
    v_lshlrev_b32 v41, 16, v115
    v_and_b32 v45, 0xffff0000, v115
    v_fma_f32 v33, v33, v125, v121
    v_fma_f32 v37, v37, v125, v121
    v_fma_f32 v41, v41, v125, v121
    v_fma_f32 v45, v45, v125, v121
    v_mul_f32 v122, v122, v126
    v_add_f32 v126, 1.0, v126
    v_lshlrev_b32 v34, 16, v116
    v_and_b32 v38, 0xffff0000, v116
    v_lshlrev_b32 v42, 16, v117
    v_and_b32 v46, 0xffff0000, v117
    v_fma_f32 v34, v34, v126, v122
    v_fma_f32 v38, v38, v126, v122
    v_fma_f32 v42, v42, v126, v122
    v_fma_f32 v46, v46, v126, v122
    v_mul_f32 v123, v123, v127
    v_add_f32 v127, 1.0, v127
    v_lshlrev_b32 v35, 16, v118
    v_and_b32 v39, 0xffff0000, v118
    v_lshlrev_b32 v43, 16, v119
    v_and_b32 v47, 0xffff0000, v119
    v_fma_f32 v35, v35, v127, v123
    v_fma_f32 v39, v39, v127, v123
    v_fma_f32 v43, v43, v127, v123
    v_fma_f32 v47, v47, v127, v123
L_noinit:
    s_cmp_eq_u32 s42, 1
    s_cbranch_scc1 L_fl_p
    buffer_load_dword v21, v16, s[44:47], s10 offen sc1
L_fl_p:
    ds_read_b128 v[160:163], v4 offset:8192
    ds_read_b128 v[164:167], v4 offset:9216
    ds_read_b128 v[168:171], v4 offset:10240
    ds_read_b128 v[172:175], v4 offset:11264
    ds_read_b128 v[176:179], v4 offset:12288
    ds_read_b128 v[180:183], v4 offset:13312
    ds_read_b128 v[184:187], v4 offset:14336
    ds_read_b128 v[188:191], v4 offset:15360
    ds_read_b128 v[192:195], v4 offset:16384
    ds_read_b128 v[196:199], v4 offset:17408
    ds_read_b128 v[200:203], v4 offset:18432
    ds_read_b128 v[204:207], v4 offset:19456
    ds_read_b128 v[208:211], v4 offset:20480
    ds_read_b128 v[212:215], v4 offset:21504
    ds_read_b128 v[216:219], v4 offset:22528
    ds_read_b128 v[220:223], v4 offset:23552
    ds_read_b128 v[224:227], v4 offset:24576
    ds_read_b128 v[228:231], v4 offset:25600
    ds_read_b128 v[232:235], v4 offset:26624
    ds_read_b128 v[236:239], v4 offset:27648
    ds_read_b128 v[240:243], v4 offset:28672
    ds_read_b128 v[244:247], v4 offset:29696
    ds_read_b128 v[248:251], v4 offset:30720
    ds_read_b128 v[252:255], v4 offset:31744
    s_cbranch_scc1 L_fl_join
    s_mov_b32 s63, 0
L_fl_poll:
    s_waitcnt vmcnt(0)
    v_cmp_eq_u32 vcc, s41, v21
    s_nop 0
    s_and_b32 s58, vcc_lo, s43
    s_cmp_eq_u32 s58, s43
    s_cbranch_scc1 L_fl_ok
    buffer_load_dword v21, v16, s[44:47], s10 offen sc1
    s_add_u32 s63, s63, 1
    s_cmp_lt_u32 s63, 40000
    s_cbranch_scc1 L_fl_poll
L_fl_ok:
    buffer_load_dwordx4 v[56:59], v6, s[44:47], s32 offen offset:0 sc1
    buffer_load_dwordx4 v[60:63], v6, s[44:47], s32 offen offset:1024 sc1
    buffer_load_dwordx4 v[64:67], v6, s[44:47], s33 offen offset:0 sc1
    buffer_load_dwordx4 v[68:71], v6, s[44:47], s33 offen offset:1024 sc1
L_fl_join:
    s_waitcnt lgkmcnt(15)
    v_mfma_f32_16x16x32_bf16 v[32:35], v[48:51], v[128:131], v[32:35]
    v_mfma_f32_16x16x32_bf16 v[36:39], v[48:51], v[132:135], v[36:39]
    v_mfma_f32_16x16x32_bf16 v[40:43], v[48:51], v[136:139], v[40:43]
    v_mfma_f32_16x16x32_bf16 v[44:47], v[48:51], v[140:143], v[44:47]
    v_mfma_f32_16x16x32_bf16 v[32:35], v[52:55], v[144:147], v[32:35]
    v_mfma_f32_16x16x32_bf16 v[36:39], v[52:55], v[148:151], v[36:39]
    v_mfma_f32_16x16x32_bf16 v[40:43], v[52:55], v[152:155], v[40:43]
    v_mfma_f32_16x16x32_bf16 v[44:47], v[52:55], v[156:159], v[44:47]
    buffer_load_dwordx4 v[72:75], v6, s[44:47], s34 offen offset:0 sc1
    s_waitcnt vmcnt(4)
    v_mfma_f32_16x16x32_bf16 v[32:35], v[56:59], v[160:163], v[32:35]
    v_mfma_f32_16x16x32_bf16 v[36:39], v[56:59], v[164:167], v[36:39]
    v_mfma_f32_16x16x32_bf16 v[40:43], v[56:59], v[168:171], v[40:43]
    v_mfma_f32_16x16x32_bf16 v[44:47], v[56:59], v[172:175], v[44:47]
    buffer_load_dwordx4 v[76:79], v6, s[44:47], s34 offen offset:1024 sc1
    s_waitcnt vmcnt(4)
    ds_read_b32 v24, v30 offset:40
    v_mfma_f32_16x16x32_bf16 v[32:35], v[60:63], v[176:179], v[32:35]
    v_mfma_f32_16x16x32_bf16 v[36:39], v[60:63], v[180:183], v[36:39]
    v_mfma_f32_16x16x32_bf16 v[40:43], v[60:63], v[184:187], v[40:43]
    v_mfma_f32_16x16x32_bf16 v[44:47], v[60:63], v[188:191], v[44:47]
    s_mov_b32 s63, 0
    s_waitcnt lgkmcnt(0)
L_wr:
    v_readfirstlane_b32 s61, v24
    s_nop 0
    s_cmp_eq_u32 s61, 0
    s_cbranch_scc1 L_wr_retry
L_wr_ok:
    buffer_load_dwordx4 v[80:83], v6, s[44:47], s35 offen offset:0 sc1
    s_waitcnt vmcnt(4)
    v_mfma_f32_16x16x32_bf16 v[32:35], v[64:67], v[192:195], v[32:35]
    ds_read_b128 v[128:131], v4 offset:32768
    v_mfma_f32_16x16x32_bf16 v[36:39], v[64:67], v[196:199], v[36:39]
    ds_read_b128 v[132:135], v4 offset:33792
    v_mfma_f32_16x16x32_bf16 v[40:43], v[64:67], v[200:203], v[40:43]
    ds_read_b128 v[136:139], v4 offset:34816
    v_mfma_f32_16x16x32_bf16 v[44:47], v[64:67], v[204:207], v[44:47]
    ds_read_b128 v[140:143], v4 offset:35840
    buffer_load_dwordx4 v[84:87], v6, s[44:47], s35 offen offset:1024 sc1
    s_waitcnt vmcnt(4)
    v_mfma_f32_16x16x32_bf16 v[32:35], v[68:71], v[208:211], v[32:35]
    ds_read_b128 v[144:147], v4 offset:36864
    v_mfma_f32_16x16x32_bf16 v[36:39], v[68:71], v[212:215], v[36:39]
    ds_read_b128 v[148:151], v4 offset:37888
    v_mfma_f32_16x16x32_bf16 v[40:43], v[68:71], v[216:219], v[40:43]
    ds_read_b128 v[152:155], v4 offset:38912
    v_mfma_f32_16x16x32_bf16 v[44:47], v[68:71], v[220:223], v[44:47]
    ds_read_b128 v[156:159], v4 offset:39936
    buffer_load_dwordx4 v[88:91], v6, s[44:47], s36 offen offset:0 sc1
    s_waitcnt vmcnt(4)
    v_mfma_f32_16x16x32_bf16 v[32:35], v[72:75], v[224:227], v[32:35]
    ds_read_b128 v[160:163], v4 offset:40960
    v_mfma_f32_16x16x32_bf16 v[36:39], v[72:75], v[228:231], v[36:39]
    ds_read_b128 v[164:167], v4 offset:41984
    v_mfma_f32_16x16x32_bf16 v[40:43], v[72:75], v[232:235], v[40:43]
    ds_read_b128 v[168:171], v4 offset:43008
    v_mfma_f32_16x16x32_bf16 v[44:47], v[72:75], v[236:239], v[44:47]
    ds_read_b128 v[172:175], v4 offset:44032
    buffer_load_dwordx4 v[92:95], v6, s[44:47], s36 offen offset:1024 sc1
    s_waitcnt vmcnt(4)
    v_mfma_f32_16x16x32_bf16 v[32:35], v[76:79], v[240:243], v[32:35]
    ds_read_b128 v[176:179], v4 offset:45056
    v_mfma_f32_16x16x32_bf16 v[36:39], v[76:79], v[244:247], v[36:39]
    ds_read_b128 v[180:183], v4 offset:46080
    v_mfma_f32_16x16x32_bf16 v[40:43], v[76:79], v[248:251], v[40:43]
    ds_read_b128 v[184:187], v4 offset:47104
    v_mfma_f32_16x16x32_bf16 v[44:47], v[76:79], v[252:255], v[44:47]
    ds_read_b128 v[188:191], v4 offset:48128
    buffer_load_dwordx4 v[96:99], v6, s[44:47], s37 offen offset:0 sc1
    s_waitcnt vmcnt(4) lgkmcnt(12)
    v_mfma_f32_16x16x32_bf16 v[32:35], v[80:83], v[128:131], v[32:35]
    ds_read_b128 v[192:195], v4 offset:49152
    v_mfma_f32_16x16x32_bf16 v[36:39], v[80:83], v[132:135], v[36:39]
    ds_read_b128 v[196:199], v4 offset:50176
    v_mfma_f32_16x16x32_bf16 v[40:43], v[80:83], v[136:139], v[40:43]
    ds_read_b128 v[200:203], v4 offset:51200
    v_mfma_f32_16x16x32_bf16 v[44:47], v[80:83], v[140:143], v[44:47]
    ds_read_b128 v[204:207], v4 offset:52224
    buffer_load_dwordx4 v[100:103], v6, s[44:47], s37 offen offset:1024 sc1
    s_waitcnt vmcnt(4) lgkmcnt(12)
    v_mfma_f32_16x16x32_bf16 v[32:35], v[84:87], v[144:147], v[32:35]
    ds_read_b128 v[208:211], v4 offset:53248
    v_mfma_f32_16x16x32_bf16 v[36:39], v[84:87], v[148:151], v[36:39]
    ds_read_b128 v[212:215], v4 offset:54272
    v_mfma_f32_16x16x32_bf16 v[40:43], v[84:87], v[152:155], v[40:43]
    ds_read_b128 v[216:219], v4 offset:55296
    v_mfma_f32_16x16x32_bf16 v[44:47], v[84:87], v[156:159], v[44:47]
    ds_read_b128 v[220:223], v4 offset:56320
    buffer_load_dwordx4 v[104:107], v6, s[44:47], s38 offen offset:0 sc1
    s_waitcnt vmcnt(4) lgkmcnt(12)
    v_mfma_f32_16x16x32_bf16 v[32:35], v[88:91], v[160:163], v[32:35]
    ds_read_b128 v[224:227], v5 offset:0
    v_mfma_f32_16x16x32_bf16 v[36:39], v[88:91], v[164:167], v[36:39]
    ds_read_b128 v[228:231], v5 offset:1024
    v_mfma_f32_16x16x32_bf16 v[40:43], v[88:91], v[168:171], v[40:43]
    ds_read_b128 v[232:235], v5 offset:2048
    v_mfma_f32_16x16x32_bf16 v[44:47], v[88:91], v[172:175], v[44:47]
    ds_read_b128 v[236:239], v5 offset:3072
    buffer_load_dwordx4 v[108:111], v6, s[44:47], s38 offen offset:1024 sc1
    s_waitcnt vmcnt(4) lgkmcnt(12)
    v_mfma_f32_16x16x32_bf16 v[32:35], v[92:95], v[176:179], v[32:35]
    ds_read_b128 v[240:243], v5 offset:4096
    v_mfma_f32_16x16x32_bf16 v[36:39], v[92:95], v[180:183], v[36:39]
    ds_read_b128 v[244:247], v5 offset:5120
    v_mfma_f32_16x16x32_bf16 v[40:43], v[92:95], v[184:187], v[40:43]
    ds_read_b128 v[248:251], v5 offset:6144
    v_mfma_f32_16x16x32_bf16 v[44:47], v[92:95], v[188:191], v[44:47]
    ds_read_b128 v[252:255], v5 offset:7168
    buffer_load_dwordx4 v[112:115], v6, s[44:47], s39 offen offset:0 sc1
    s_waitcnt vmcnt(4) lgkmcnt(12)
    v_mfma_f32_16x16x32_bf16 v[32:35], v[96:99], v[192:195], v[32:35]
    ds_read_b128 v[128:131], v5 offset:8192
    v_mfma_f32_16x16x32_bf16 v[36:39], v[96:99], v[196:199], v[36:39]
    ds_read_b128 v[132:135], v5 offset:9216
    v_mfma_f32_16x16x32_bf16 v[40:43], v[96:99], v[200:203], v[40:43]
    ds_read_b128 v[136:139], v5 offset:10240
    v_mfma_f32_16x16x32_bf16 v[44:47], v[96:99], v[204:207], v[44:47]
    ds_read_b128 v[140:143], v5 offset:11264
    buffer_load_dwordx4 v[116:119], v6, s[44:47], s39 offen offset:1024 sc1
    s_waitcnt vmcnt(4) lgkmcnt(12)
    v_mfma_f32_16x16x32_bf16 v[32:35], v[100:103], v[208:211], v[32:35]
    ds_read_b128 v[144:147], v5 offset:12288
    v_mfma_f32_16x16x32_bf16 v[36:39], v[100:103], v[212:215], v[36:39]
    ds_read_b128 v[148:151], v5 offset:13312
    v_mfma_f32_16x16x32_bf16 v[40:43], v[100:103], v[216:219], v[40:43]
    ds_read_b128 v[152:155], v5 offset:14336
    v_mfma_f32_16x16x32_bf16 v[44:47], v[100:103], v[220:223], v[44:47]
    ds_read_b128 v[156:159], v5 offset:15360
    buffer_load_dwordx4 v[120:123], v6, s[44:47], s40 offen offset:0 sc1
    s_waitcnt vmcnt(4) lgkmcnt(12)
    v_mfma_f32_16x16x32_bf16 v[32:35], v[104:107], v[224:227], v[32:35]
    ds_read_b128 v[160:163], v5 offset:16384
    v_mfma_f32_16x16x32_bf16 v[36:39], v[104:107], v[228:231], v[36:39]
    ds_read_b128 v[164:167], v5 offset:17408
    v_mfma_f32_16x16x32_bf16 v[40:43], v[104:107], v[232:235], v[40:43]
    ds_read_b128 v[168:171], v5 offset:18432
    v_mfma_f32_16x16x32_bf16 v[44:47], v[104:107], v[236:239], v[44:47]
    ds_read_b128 v[172:175], v5 offset:19456
    buffer_load_dwordx4 v[124:127], v6, s[44:47], s40 offen offset:1024 sc1
    s_waitcnt vmcnt(4) lgkmcnt(12)
    v_mfma_f32_16x16x32_bf16 v[32:35], v[108:111], v[240:243], v[32:35]
    ds_read_b128 v[176:179], v3 offset:0
    v_mfma_f32_16x16x32_bf16 v[36:39], v[108:111], v[244:247], v[36:39]
    ds_read_b128 v[180:183], v3 offset:1024
    v_mfma_f32_16x16x32_bf16 v[40:43], v[108:111], v[248:251], v[40:43]
    ds_read_b128 v[184:187], v3 offset:2048
    v_mfma_f32_16x16x32_bf16 v[44:47], v[108:111], v[252:255], v[44:47]
    ds_read_b128 v[188:191], v3 offset:3072
    s_waitcnt vmcnt(3) lgkmcnt(12)
    ds_read_b128 v[24:27], v30 offset:16
    v_mfma_f32_16x16x32_bf16 v[32:35], v[112:115], v[128:131], v[32:35]
    v_mfma_f32_16x16x32_bf16 v[36:39], v[112:115], v[132:135], v[36:39]
    v_mfma_f32_16x16x32_bf16 v[40:43], v[112:115], v[136:139], v[40:43]
    v_mfma_f32_16x16x32_bf16 v[44:47], v[112:115], v[140:143], v[44:47]
    s_waitcnt vmcnt(2) lgkmcnt(8)
    v_mfma_f32_16x16x32_bf16 v[32:35], v[116:119], v[144:147], v[32:35]
    v_mfma_f32_16x16x32_bf16 v[36:39], v[116:119], v[148:151], v[36:39]
    v_mfma_f32_16x16x32_bf16 v[40:43], v[116:119], v[152:155], v[40:43]
    v_mfma_f32_16x16x32_bf16 v[44:47], v[116:119], v[156:159], v[44:47]
    s_mov_b32 s63, 0
    s_waitcnt lgkmcnt(0)
L_rdy:
    v_readfirstlane_b32 s61, v27
    v_readfirstlane_b32 s57, v25
    v_readfirstlane_b32 s62, v26
    s_cmp_eq_u32 s61, 0
    s_cbranch_scc1 L_rdy_retry
L_rdy_ok:
    s_lshr_b32 s58, s57, 4
    s_lshr_b32 s59, s62, 4
    s_cmp_eq_u32 s58, s28
    s_cselect_b32 s56, 1, 0
    s_cmp_eq_u32 s59, s28
    s_cselect_b32 s56, 1, s56
    s_cmp_eq_u32 s56, 0
    s_cbranch_scc1 L_ynf
    v_lshlrev_b32 v20, 2, v2
    v_lshl_add_u32 v20, s28, 4, v20
    v_lshlrev_b32 v21, 4, v1
    v_add_u32 v21, 161024, v21
    v_add_u32 v22, 256, v21
    v_add_u32 v23, 512, v21
    v_cmp_eq_u32 vcc, s62, v20
    v_cmp_eq_u32 s[58:59], s57, v20
    v_add_u32 v20, 1, v20
    v_cndmask_b32 v64, v23, v22, vcc
    v_cndmask_b32 v64, v64, v21, s[58:59]
    v_cmp_eq_u32 vcc, s62, v20
    v_cmp_eq_u32 s[58:59], s57, v20
    v_add_u32 v20, 1, v20
    v_cndmask_b32 v65, v23, v22, vcc
    v_cndmask_b32 v65, v65, v21, s[58:59]
    v_cmp_eq_u32 vcc, s62, v20
    v_cmp_eq_u32 s[58:59], s57, v20
    v_add_u32 v20, 1, v20
    v_cndmask_b32 v66, v23, v22, vcc
    v_cndmask_b32 v66, v66, v21, s[58:59]
    v_cmp_eq_u32 vcc, s62, v20
    v_cmp_eq_u32 s[58:59], s57, v20
    v_add_u32 v20, 1, v20
    v_cndmask_b32 v67, v23, v22, vcc
    v_cndmask_b32 v67, v67, v21, s[58:59]
    ds_read_b32 v20, v30 offset:32
    ds_read_b128 v[48:51], v64
    ds_read_b128 v[52:55], v65
    ds_read_b128 v[56:59], v66
    ds_read_b128 v[60:63], v67
L_ynf:
    s_waitcnt vmcnt(1)
    v_mfma_f32_16x16x32_bf16 v[32:35], v[120:123], v[160:163], v[32:35]
    v_mfma_f32_16x16x32_bf16 v[36:39], v[120:123], v[164:167], v[36:39]
    v_mfma_f32_16x16x32_bf16 v[40:43], v[120:123], v[168:171], v[40:43]
    v_mfma_f32_16x16x32_bf16 v[44:47], v[120:123], v[172:175], v[44:47]
    s_waitcnt vmcnt(0)
    v_mfma_f32_16x16x32_bf16 v[32:35], v[124:127], v[176:179], v[32:35]
    v_mfma_f32_16x16x32_bf16 v[36:39], v[124:127], v[180:183], v[36:39]
    v_mfma_f32_16x16x32_bf16 v[40:43], v[124:127], v[184:187], v[40:43]
    v_mfma_f32_16x16x32_bf16 v[44:47], v[124:127], v[188:191], v[44:47]
    s_cmp_eq_u32 s56, 0
    s_cbranch_scc1 L_noy
    s_mov_b32 s63, 0
L_yw:
    s_waitcnt lgkmcnt(0)
    v_readfirstlane_b32 s61, v20
    s_nop 0
    s_cmp_eq_u32 s61, 0
    s_cbranch_scc1 L_yretry
L_yok:
    v_add_f32 v32, v32, v48
    v_add_f32 v33, v33, v52
    v_add_f32 v34, v34, v56
    v_add_f32 v35, v35, v60
    v_add_f32 v36, v36, v49
    v_add_f32 v37, v37, v53
    v_add_f32 v38, v38, v57
    v_add_f32 v39, v39, v61
    v_add_f32 v40, v40, v50
    v_add_f32 v41, v41, v54
    v_add_f32 v42, v42, v58
    v_add_f32 v43, v43, v62
    v_add_f32 v44, v44, v51
    v_add_f32 v45, v45, v55
    v_add_f32 v46, v46, v59
    v_add_f32 v47, v47, v63
L_noy:
    s_nop 3
    v_cvt_pk_bf16_f32 v72, v32, v36
    v_cvt_pk_bf16_f32 v74, v33, v37
    v_cvt_pk_bf16_f32 v76, v34, v38
    v_cvt_pk_bf16_f32 v78, v35, v39
    v_cvt_pk_bf16_f32 v73, v40, v44
    buffer_store_dwordx2 v[72:73], v12, s[48:51], s14 offen offset:0 nt
    v_cvt_pk_bf16_f32 v75, v41, v45
    buffer_store_dwordx2 v[74:75], v13, s[48:51], s14 offen offset:1280 nt
    v_cvt_pk_bf16_f32 v77, v42, v46
    buffer_store_dwordx2 v[76:77], v14, s[48:51], s14 offen offset:2560 nt
    v_cvt_pk_bf16_f32 v79, v43, v47
    buffer_store_dwordx2 v[78:79], v15, s[48:51], s14 offen offset:3840 nt
    s_endpgm
L_aux_pre:
    s_mov_b32 s3, 2
    s_sub_u32 s62, s26, 4
    v_mov_b32 v32, 0x3f803f80
    v_mov_b32 v33, v32
    v_mov_b32 v34, v32
    v_mov_b32 v35, v32
    v_lshrrev_b32 v36, 3, v0
    v_min_u32 v36, 2, v36
    v_mul_u32_u24 v36, 38912, v36
    v_and_b32 v37, 7, v0
    v_lshl_add_u32 v36, v37, 4, v36
    ds_write_b128 v36, v[32:35] offset:24576
    v_mov_b32 v36, 160768
    v_mov_b32 v37, 0
    ds_write_b32 v36, v37 offset:28
    ds_write_b32 v36, v37 offset:32
    ds_write_b32 v36, v37 offset:36
    ds_write_b32 v36, v37 offset:40
    v_mov_b64 v[48:49], 0
    v_mov_b64 v[50:51], 0
    s_mul_i32 s58, s62, 14336
    s_add_u32 s58, s58, 129024
    v_lshl_add_u32 v52, v0, 4, s58
    ds_write_b128 v52, v[48:51]
    ds_write_b128 v52, v[48:51] offset:1024
    v_lshrrev_b32 v38, 4, v0
    v_lshlrev_b32 v38, 4, v38
    s_mov_b32 s58, 3997696
    s_lshl_b32 s59, s31, 7
    s_waitcnt lgkmcnt(0)
    s_mov_b64 s[44:45], s[24:25]
    s_mov_b32 s46, 5184512
    s_mov_b32 s47, 0x00020000
    s_mov_b64 s[36:37], s[12:13]
    s_mov_b32 s38, 1280
    s_mov_b32 s39, 0x00020000
    s_mov_b64 s[40:41], s[8:9]
    s_mov_b32 s42, 819200
    s_mov_b32 s43, 0x00020000
    buffer_load_dword v39, v37, s[44:47], s58 offen sc1
    buffer_load_dwordx4 v[40:43], v38, s[36:39], s59 offen
    buffer_load_dwordx4 v[44:47], v38, s[36:39], s59 offen offset:64
    s_cmp_eq_u32 s26, 4
    s_cbranch_scc1 L_aux_wt
    v_mov_b64 v[34:35], -1
    v_lshlrev_b32 v33, 3, v0
    s_mul_i32 s58, s29, 10
    s_add_u32 s58, s58, s76
    s_lshl_b32 s58, s58, 9
    s_add_u32 s58, s58, 4063232
    buffer_store_dwordx2 v[34:35], v33, s[44:47], s58 offen sc1
    s_branch L_const
L_aux_wt:
    v_lshrrev_b32 v33, 3, v0
    v_and_b32 v34, 7, v0
    v_mul_u32_u24 v33, 1280, v33
    v_lshl_add_u32 v33, v34, 4, v33
    s_mul_i32 s58, s29, 40960
    s_lshl_b32 s59, s30, 7
    s_add_u32 s58, s58, s59
    s_mov_b32 m0, 116736
    s_nop 0
    buffer_load_dwordx4 v33, s[40:43], s58 offen lds
    s_add_u32 m0, m0, 1024
    s_add_u32 s58, s58, 10240
    buffer_load_dwordx4 v33, s[40:43], s58 offen lds
    s_add_u32 m0, m0, 1024
    s_add_u32 s58, s58, 10240
    buffer_load_dwordx4 v33, s[40:43], s58 offen lds
    s_add_u32 m0, m0, 1024
    s_add_u32 s58, s58, 10240
    buffer_load_dwordx4 v33, s[40:43], s58 offen lds
    s_branch L_const
L_aux:
    s_lshl_b32 s58, s62, 13
    s_sub_u32 s58, s58, s79
    s_sub_u32 s58, s58, 92160
    v_add_u32 v20, s58, v198
    v_add_u32 v21, s58, v199
    s_mov_b32 s57, 0x3f803f80
    s_getreg_b32 s61, hwreg(HW_REG_XCC_ID, 0, 3)
    s_mul_i32 s59, s29, 10
    s_add_u32 s59, s59, s30
    s_lshl_b32 s59, s59, 12
    s_lshl_b32 s60, s62, 10
    s_add_u32 s59, s59, s60
    s_add_u32 s59, s59, 3014656
    s_lshl_b32 s56, s29, 11
    s_add_u32 s60, s60, s56
    s_add_u32 s60, s60, 3932160
    s_lshl_b32 s58, s62, 11
    v_subrev_u32 v24, s58, v20
    v_subrev_u32 v25, s58, v21
    s_setprio 2
    s_cmp_eq_u32 s26, 4
    s_cbranch_scc1 L_aux_w
    s_waitcnt vmcnt(4)
L_aux_w:
    s_waitcnt vmcnt(7)
    s_barrier
    ds_read_b128 v[64:67], v20 offset:0
    ds_read_b128 v[68:71], v20 offset:2048
    ds_read_b128 v[72:75], v20 offset:4096
    ds_read_b128 v[76:79], v24 offset:6144
    ds_read_b128 v[80:83], v21 offset:0
    ds_read_b128 v[84:87], v21 offset:2048
    ds_read_b128 v[88:91], v21 offset:4096
    ds_read_b128 v[92:95], v25 offset:6144
    s_waitcnt vmcnt(0)
    v_readfirstlane_b32 s56, v39
    v_mov_b32 v48, s57
    v_and_b32 v49, 3, v1
    v_lshrrev_b32 v50, 2, v1
    v_cmp_eq_u32 vcc, 0, v49
    s_add_u32 s56, s56, 8
    s_and_b32 s56, s56, -8
    s_xor_b32 s56, s56, 0x5a3c9658
    s_or_b32 s61, s61, s56
    v_cndmask_b32 v40, v40, v48, vcc
    v_cndmask_b32 v41, v41, v48, vcc
    v_cndmask_b32 v42, v42, v48, vcc
    v_cndmask_b32 v43, v43, v48, vcc
    v_cndmask_b32 v44, v44, v48, vcc
    v_cndmask_b32 v45, v45, v48, vcc
    v_cndmask_b32 v46, v46, v48, vcc
    v_cndmask_b32 v47, v47, v48, vcc
    s_mov_b32 s16, 0x30003
    s_mov_b32 s17, 0x30003
    v_cndmask_b32 v96, 0, v40, s[16:17]
    v_cndmask_b32 v97, 0, v41, s[16:17]
    v_cndmask_b32 v98, 0, v42, s[16:17]
    v_cndmask_b32 v99, 0, v43, s[16:17]
    v_cndmask_b32 v100, 0, v44, s[16:17]
    v_cndmask_b32 v101, 0, v45, s[16:17]
    v_cndmask_b32 v102, 0, v46, s[16:17]
    v_cndmask_b32 v103, 0, v47, s[16:17]
    s_mov_b32 s16, 0x300030
    s_mov_b32 s17, 0x300030
    v_cndmask_b32 v104, 0, v40, s[16:17]
    v_cndmask_b32 v105, 0, v41, s[16:17]
    v_cndmask_b32 v106, 0, v42, s[16:17]
    v_cndmask_b32 v107, 0, v43, s[16:17]
    v_cndmask_b32 v108, 0, v44, s[16:17]
    v_cndmask_b32 v109, 0, v45, s[16:17]
    v_cndmask_b32 v110, 0, v46, s[16:17]
    v_cndmask_b32 v111, 0, v47, s[16:17]
    s_mov_b32 s16, 0x3000300
    s_mov_b32 s17, 0x3000300
    v_cndmask_b32 v112, 0, v40, s[16:17]
    v_cndmask_b32 v113, 0, v41, s[16:17]
    v_cndmask_b32 v114, 0, v42, s[16:17]
    v_cndmask_b32 v115, 0, v43, s[16:17]
    v_cndmask_b32 v116, 0, v44, s[16:17]
    v_cndmask_b32 v117, 0, v45, s[16:17]
    v_cndmask_b32 v118, 0, v46, s[16:17]
    v_cndmask_b32 v119, 0, v47, s[16:17]
    s_mov_b32 s16, 0x30003000
    s_mov_b32 s17, 0x30003000
    v_cndmask_b32 v120, 0, v40, s[16:17]
    v_cndmask_b32 v121, 0, v41, s[16:17]
    v_cndmask_b32 v122, 0, v42, s[16:17]
    v_cndmask_b32 v123, 0, v43, s[16:17]
    v_cndmask_b32 v124, 0, v44, s[16:17]
    v_cndmask_b32 v125, 0, v45, s[16:17]
    v_cndmask_b32 v126, 0, v46, s[16:17]
    v_cndmask_b32 v127, 0, v47, s[16:17]
    s_mov_b32 s16, 0xaaaaaaaa
    s_mov_b32 s17, 0xaaaaaaaa
    s_mov_b32 s18, 0xcccccccc
    s_mov_b32 s19, 0xcccccccc
    v_cmp_eq_u32 vcc, v50, v2
    s_waitcnt lgkmcnt(0)
    s_barrier
    s_waitcnt lgkmcnt(7)
    v_mfma_f32_16x16x32_bf16 v[128:131], v[64:67], v[64:67], 0
    v_mfma_f32_16x16x32_bf16 v[56:59], v[96:99], v[64:67], 0
    s_waitcnt lgkmcnt(6)
    v_mfma_f32_16x16x32_bf16 v[132:135], v[68:71], v[68:71], 0
    v_mfma_f32_16x16x32_bf16 v[56:59], v[104:107], v[68:71], v[56:59]
    s_waitcnt lgkmcnt(5)
    v_mfma_f32_16x16x32_bf16 v[136:139], v[72:75], v[72:75], 0
    v_mfma_f32_16x16x32_bf16 v[56:59], v[112:115], v[72:75], v[56:59]
    s_waitcnt lgkmcnt(4)
    v_mfma_f32_16x16x32_bf16 v[140:143], v[76:79], v[76:79], 0
    v_mfma_f32_16x16x32_bf16 v[56:59], v[120:123], v[76:79], v[56:59]
    s_waitcnt lgkmcnt(3)
    v_mfma_f32_16x16x32_bf16 v[128:131], v[80:83], v[80:83], v[128:131]
    v_mfma_f32_16x16x32_bf16 v[56:59], v[100:103], v[80:83], v[56:59]
    s_waitcnt lgkmcnt(2)
    v_mfma_f32_16x16x32_bf16 v[132:135], v[84:87], v[84:87], v[132:135]
    v_mfma_f32_16x16x32_bf16 v[56:59], v[108:111], v[84:87], v[56:59]
    s_waitcnt lgkmcnt(1)
    v_mfma_f32_16x16x32_bf16 v[136:139], v[88:91], v[88:91], v[136:139]
    v_mfma_f32_16x16x32_bf16 v[56:59], v[116:119], v[88:91], v[56:59]
    s_waitcnt lgkmcnt(0)
    v_mfma_f32_16x16x32_bf16 v[140:143], v[92:95], v[92:95], v[140:143]
    v_mfma_f32_16x16x32_bf16 v[56:59], v[124:127], v[92:95], v[56:59]
    v_cndmask_b32 v128, v128, v129, s[16:17]
    v_cndmask_b32 v130, v130, v131, s[16:17]
    v_cndmask_b32 v128, v128, v130, s[18:19]
    v_cndmask_b32 v52, 0, v128, vcc
    v_cndmask_b32 v132, v132, v133, s[16:17]
    v_cndmask_b32 v134, v134, v135, s[16:17]
    v_cndmask_b32 v132, v132, v134, s[18:19]
    v_cndmask_b32 v53, 0, v132, vcc
    v_cndmask_b32 v136, v136, v137, s[16:17]
    v_cndmask_b32 v138, v138, v139, s[16:17]
    v_cndmask_b32 v136, v136, v138, s[18:19]
    v_cndmask_b32 v54, 0, v136, vcc
    v_cndmask_b32 v140, v140, v141, s[16:17]
    v_cndmask_b32 v142, v142, v143, s[16:17]
    v_cndmask_b32 v140, v140, v142, s[18:19]
    v_cndmask_b32 v55, 0, v140, vcc
    v_mov_b32 v60, v56
    v_mov_b32 v62, v57
    v_permlane32_swap_b32 v52, v54
    v_permlane32_swap_b32 v53, v55
    v_add_f32 v52, v52, v54
    v_add_f32 v53, v53, v55
    s_nop 1
    v_permlane16_swap_b32 v52, v53
    v_add_f32 v61, v52, v53
    v_mov_b32 v63, s61
    buffer_store_dwordx4 v[60:63], v3, s[44:47], s59 offen
    s_add_u32 s59, s59, 2048
    buffer_store_dwordx4 v[60:63], v3, s[44:47], s59 offen sc1
    s_setprio 0
    s_barrier
    s_cmp_eq_u32 s26, 4
    s_cbranch_scc0 L_aux_nt
    v_lshlrev_b32 v26, 9, v2
    v_lshl_add_u32 v26, v1, 3, v26
    v_add_u32 v26, 116736, v26
    s_mov_b32 s16, 0x05040100
    s_mov_b32 s17, 0x07060302
    s_mul_i32 s58, s30, 81920
    s_lshl_b32 s59, s29, 12
    s_add_u32 s58, s58, s59
    s_add_u32 s58, s58, 4194304
    s_cmp_ge_u32 s29, 20
    s_cselect_b32 s58, 2147418112, s58
    ds_read_b64 v[96:97], v26 offset:0
    ds_read_b64 v[98:99], v26 offset:128
    ds_read_b64 v[100:101], v26 offset:256
    ds_read_b64 v[102:103], v26 offset:384
    ds_read_b64 v[104:105], v26 offset:2048
    ds_read_b64 v[106:107], v26 offset:2176
    ds_read_b64 v[108:109], v26 offset:2304
    ds_read_b64 v[110:111], v26 offset:2432
    s_waitcnt lgkmcnt(0)
    v_perm_b32 v68, v98, v96, s16
    v_perm_b32 v69, v102, v100, s16
    v_perm_b32 v70, v106, v104, s16
    v_perm_b32 v71, v110, v108, s16
    buffer_store_dwordx4 v[68:71], v3, s[44:47], s58 offen offset:0 sc1
    v_perm_b32 v72, v98, v96, s17
    v_perm_b32 v73, v102, v100, s17
    v_perm_b32 v74, v106, v104, s17
    v_perm_b32 v75, v110, v108, s17
    buffer_store_dwordx4 v[72:75], v3, s[44:47], s58 offen offset:1024 sc1
    v_perm_b32 v76, v99, v97, s16
    v_perm_b32 v77, v103, v101, s16
    v_perm_b32 v78, v107, v105, s16
    v_perm_b32 v79, v111, v109, s16
    buffer_store_dwordx4 v[76:79], v3, s[44:47], s58 offen offset:2048 sc1
    v_perm_b32 v80, v99, v97, s17
    v_perm_b32 v81, v103, v101, s17
    v_perm_b32 v82, v107, v105, s17
    v_perm_b32 v83, v111, v109, s17
    buffer_store_dwordx4 v[80:83], v3, s[44:47], s58 offen offset:3072 sc1
L_aux_nt:
    s_mov_b32 s3, 6
    s_add_u32 s16, s79, 116736
    s_branch L_constB
L_aux2:
    s_setprio 0
    s_lshl_b32 s61, s76, 7
    s_add_u32 s61, s61, 4001792
    v_min_u32 v22, 19, v0
    v_lshlrev_b32 v22, 2, v22
    buffer_load_dwordx4 v[64:67], v3, s[44:47], s60 offen sc1
    buffer_load_dword v68, v22, s[44:47], s61 offen sc1
    s_lshl_b32 s58, s62, 8
    s_add_u32 s58, s58, 159744
    v_lshl_add_u32 v20, v0, 2, s58
    v_mov_b32 v21, 160768
    s_barrier
    s_mov_b32 s63, 0
L_sf:
    s_waitcnt vmcnt(0)
    v_cmp_ne_u32 vcc, s56, v67
    v_cmp_ne_u32 s[58:59], s56, v68
    s_add_u32 s63, s63, 1
    s_or_b64 s[58:59], s[58:59], vcc
    s_cbranch_scc0 L_sf_ok
    s_cmp_ge_u32 s63, 40000
    s_cbranch_scc1 L_sf_ok
    buffer_load_dwordx4 v[64:67], v3, s[44:47], s60 offen sc1
    buffer_load_dword v68, v22, s[44:47], s61 offen sc1
    s_branch L_sf
L_sf_ok:

    ds_write_b32 v20, v64
    ds_write_b32 v20, v65 offset:512
    ds_write_b64 v21, v[66:67]
    s_waitcnt lgkmcnt(0)
    s_barrier
    s_mul_i32 s58, s27, 3
    s_sub_u32 s58, 18, s58
    s_sub_u32 s58, s29, s58
    s_lshl_b32 s58, s58, 1
    s_add_u32 s58, s58, s62
    s_add_u32 s58, s58, s30
    s_add_u32 s58, s58, 4
    s_cmp_ge_u32 s58, 10
    s_cselect_b32 s59, 10, 0
    s_sub_u32 s58, s58, s59
    s_lshl_b32 s58, s58, 13
    s_mul_i32 s59, s76, 81920
    s_add_u32 s58, s58, s59
    s_add_u32 s58, s58, 4194304
    v_lshlrev_b32 v21, 7, v0
    s_barrier
    buffer_load_dword v106, v21, s[44:47], s58 offen sc1
    s_branch L_a_pre
L_w3:
    s_setprio 3
    s_mov_b64 s[52:53], s[22:23]
    s_mov_b32 s54, 256
    s_mov_b32 s55, 0x00020000
    v_lshlrev_b32 v5, 2, v0
    v_cmp_gt_u32 vcc, 14, v0
    v_mov_b32 v6, 2147418112
    s_nop 0
    v_cndmask_b32 v5, v6, v5, vcc
    buffer_load_dword v4, v5, s[52:55], 0 offen sc1
    s_mul_i32 s58, s76, 81920
    s_add_u32 s58, s58, 4194304
    v_lshl_add_u32 v32, v0, 4, s58
    s_add_u32 s58, s30, 3
    s_cmp_ge_u32 s58, 10
    s_cselect_b32 s59, 10, 0
    s_sub_u32 s58, s58, s59
    s_lshl_b32 s67, s58, 13
    v_add_u32 v33, 1024, v32
    v_add_u32 v34, 2048, v32
    v_add_u32 v35, 3072, v32
    v_add_u32 v36, 4096, v32
    v_add_u32 v37, 5120, v32
    v_add_u32 v38, 6144, v32
    v_add_u32 v39, 7168, v32
    s_add_u32 s68, s67, 8192
    s_cmp_eq_u32 s68, 81920
    s_cselect_b32 s68, 0, s68
    s_add_u32 s69, s68, 8192
    s_cmp_eq_u32 s69, 81920
    s_cselect_b32 s69, 0, s69
    s_add_u32 s70, s69, 8192
    s_cmp_eq_u32 s70, 81920
    s_cselect_b32 s70, 0, s70
    s_add_u32 s71, s70, 8192
    s_cmp_eq_u32 s71, 81920
    s_cselect_b32 s71, 0, s71
    s_add_u32 s72, s71, 8192
    s_cmp_eq_u32 s72, 81920
    s_cselect_b32 s72, 0, s72
    s_add_u32 s73, s72, 8192
    s_cmp_eq_u32 s73, 81920
    s_cselect_b32 s73, 0, s73
    s_mov_b32 m0, 71680
    s_nop 0
    buffer_load_dwordx4 v32, s[44:47], s68 offen sc1 lds
    s_add_u32 m0, m0, 1024
    s_waitcnt vmcnt(16)
    buffer_load_dwordx4 v33, s[44:47], s68 offen sc1 lds
    s_add_u32 m0, m0, 1024
    s_waitcnt vmcnt(16)
    buffer_load_dwordx4 v34, s[44:47], s68 offen sc1 lds
    s_add_u32 m0, m0, 1024
    s_waitcnt vmcnt(16)
    buffer_load_dwordx4 v35, s[44:47], s68 offen sc1 lds
    s_add_u32 m0, m0, 1024
    s_waitcnt vmcnt(16)
    buffer_load_dwordx4 v36, s[44:47], s68 offen sc1 lds
    s_add_u32 m0, m0, 1024
    s_waitcnt vmcnt(16)
    buffer_load_dwordx4 v37, s[44:47], s68 offen sc1 lds
    s_add_u32 m0, m0, 1024
    s_waitcnt vmcnt(16)
    buffer_load_dwordx4 v38, s[44:47], s68 offen sc1 lds
    s_add_u32 m0, m0, 1024
    s_waitcnt vmcnt(16)
    buffer_load_dwordx4 v39, s[44:47], s68 offen sc1 lds
    s_add_u32 m0, m0, 1024
    s_waitcnt vmcnt(16)
    buffer_load_dwordx4 v32, s[44:47], s69 offen sc1 lds
    s_add_u32 m0, m0, 1024
    s_waitcnt vmcnt(16)
    buffer_load_dwordx4 v33, s[44:47], s69 offen sc1 lds
    s_add_u32 m0, m0, 1024
    s_waitcnt vmcnt(16)
    buffer_load_dwordx4 v34, s[44:47], s69 offen sc1 lds
    s_add_u32 m0, m0, 1024
    s_waitcnt vmcnt(16)
    buffer_load_dwordx4 v35, s[44:47], s69 offen sc1 lds
    s_add_u32 m0, m0, 1024
    s_waitcnt vmcnt(16)
    buffer_load_dwordx4 v36, s[44:47], s69 offen sc1 lds
    s_add_u32 m0, m0, 1024
    s_waitcnt vmcnt(16)
    buffer_load_dwordx4 v37, s[44:47], s69 offen sc1 lds
    s_add_u32 m0, m0, 1024
    s_waitcnt vmcnt(16)
    buffer_load_dwordx4 v38, s[44:47], s69 offen sc1 lds
    s_add_u32 m0, m0, 1024
    s_waitcnt vmcnt(16)
    buffer_load_dwordx4 v39, s[44:47], s69 offen sc1 lds
    s_add_u32 m0, m0, 1024
    s_waitcnt vmcnt(16)
    buffer_load_dwordx4 v32, s[44:47], s70 offen sc1 lds
    s_add_u32 m0, m0, 1024
    s_waitcnt vmcnt(16)
    buffer_load_dwordx4 v33, s[44:47], s70 offen sc1 lds
    s_add_u32 m0, m0, 1024
    s_waitcnt vmcnt(16)
    buffer_load_dwordx4 v34, s[44:47], s70 offen sc1 lds
    s_add_u32 m0, m0, 1024
    s_waitcnt vmcnt(16)
    buffer_load_dwordx4 v35, s[44:47], s70 offen sc1 lds
    s_add_u32 m0, m0, 1024
    s_waitcnt vmcnt(16)
    buffer_load_dwordx4 v36, s[44:47], s70 offen sc1 lds
    s_add_u32 m0, m0, 1024
    s_waitcnt vmcnt(16)
    buffer_load_dwordx4 v37, s[44:47], s70 offen sc1 lds
    s_add_u32 m0, m0, 1024
    s_waitcnt vmcnt(16)
    buffer_load_dwordx4 v38, s[44:47], s70 offen sc1 lds
    s_add_u32 m0, m0, 1024
    s_waitcnt vmcnt(16)
    buffer_load_dwordx4 v39, s[44:47], s70 offen sc1 lds
    s_add_u32 m0, m0, 1024
    s_waitcnt vmcnt(16)
    buffer_load_dwordx4 v32, s[44:47], s71 offen sc1 lds
    s_add_u32 m0, m0, 1024
    s_waitcnt vmcnt(16)
    buffer_load_dwordx4 v33, s[44:47], s71 offen sc1 lds
    s_add_u32 m0, m0, 1024
    s_waitcnt vmcnt(16)
    buffer_load_dwordx4 v34, s[44:47], s71 offen sc1 lds
    s_add_u32 m0, m0, 1024
    s_waitcnt vmcnt(16)
    buffer_load_dwordx4 v35, s[44:47], s71 offen sc1 lds
    s_add_u32 m0, m0, 1024
    s_waitcnt vmcnt(16)
    buffer_load_dwordx4 v36, s[44:47], s71 offen sc1 lds
    s_add_u32 m0, m0, 1024
    s_waitcnt vmcnt(16)
    buffer_load_dwordx4 v37, s[44:47], s71 offen sc1 lds
    s_add_u32 m0, m0, 1024
    s_waitcnt vmcnt(16)
    buffer_load_dwordx4 v38, s[44:47], s71 offen sc1 lds
    s_add_u32 m0, m0, 1024
    s_waitcnt vmcnt(16)
    buffer_load_dwordx4 v39, s[44:47], s71 offen sc1 lds
    s_add_u32 m0, m0, 1024
    s_waitcnt vmcnt(16)
    buffer_load_dwordx4 v32, s[44:47], s72 offen sc1 lds
    s_add_u32 m0, m0, 1024
    s_waitcnt vmcnt(16)
    buffer_load_dwordx4 v33, s[44:47], s72 offen sc1 lds
    s_add_u32 m0, m0, 1024
    s_waitcnt vmcnt(16)
    buffer_load_dwordx4 v34, s[44:47], s72 offen sc1 lds
    s_add_u32 m0, m0, 1024
    s_waitcnt vmcnt(16)
    buffer_load_dwordx4 v35, s[44:47], s72 offen sc1 lds
    s_add_u32 m0, m0, 1024
    s_waitcnt vmcnt(16)
    buffer_load_dwordx4 v36, s[44:47], s72 offen sc1 lds
    s_add_u32 m0, m0, 1024
    s_waitcnt vmcnt(16)
    buffer_load_dwordx4 v37, s[44:47], s72 offen sc1 lds
    s_add_u32 m0, m0, 1024
    s_waitcnt vmcnt(16)
    buffer_load_dwordx4 v38, s[44:47], s72 offen sc1 lds
    s_add_u32 m0, m0, 1024
    s_waitcnt vmcnt(16)
    buffer_load_dwordx4 v39, s[44:47], s72 offen sc1 lds
    s_add_u32 m0, m0, 1024
    s_waitcnt vmcnt(16)
    buffer_load_dwordx4 v32, s[44:47], s73 offen sc1 lds
    s_add_u32 m0, m0, 1024
    s_waitcnt vmcnt(16)
    buffer_load_dwordx4 v33, s[44:47], s73 offen sc1 lds
    s_add_u32 m0, m0, 1024
    s_waitcnt vmcnt(16)
    buffer_load_dwordx4 v34, s[44:47], s73 offen sc1 lds
    s_add_u32 m0, m0, 1024
    s_waitcnt vmcnt(16)
    buffer_load_dwordx4 v35, s[44:47], s73 offen sc1 lds
    s_waitcnt vmcnt(16)
    s_mov_b32 m0, 0
    s_nop 0
    buffer_load_dwordx4 v36, s[44:47], s73 offen sc1 lds
    s_add_u32 m0, m0, 1024
    s_nop 0
    buffer_load_dwordx4 v37, s[44:47], s73 offen sc1 lds
    s_add_u32 m0, m0, 1024
    s_nop 0
    buffer_load_dwordx4 v38, s[44:47], s73 offen sc1 lds
    s_add_u32 m0, m0, 1024
    s_nop 0
    buffer_load_dwordx4 v39, s[44:47], s73 offen sc1 lds
    v_mov_b32 v11, 1
    s_waitcnt vmcnt(0)
    ds_write_b32 v30, v11 offset:40
    s_mov_b32 s58, 0
L_pk_w7:
    s_waitcnt vmcnt(0)
    v_cmp_ne_u32 vcc, 0, v4
    s_add_u32 s58, s58, 1
    s_cmp_eq_u32 vcc_lo, 0x3fff
    s_cbranch_scc1 L_pkd_w7
    s_cmp_ge_u32 s58, 40000
    s_cbranch_scc1 L_pkd_w7

    buffer_load_dword v4, v5, s[52:55], 0 offen sc1
    s_branch L_pk_w7
L_pkd_w7:
    v_mov_b32 v6, v4
    s_nop 1
    v_max_u32_dpp v6, v6, v6 row_ror:8 row_mask:0xf bank_mask:0xf
    s_nop 1
    v_max_u32_dpp v6, v6, v6 row_ror:4 row_mask:0xf bank_mask:0xf
    s_nop 1
    v_max_u32_dpp v6, v6, v6 row_ror:2 row_mask:0xf bank_mask:0xf
    s_nop 1
    v_max_u32_dpp v6, v6, v6 row_ror:1 row_mask:0xf bank_mask:0xf
    s_nop 0
    v_readlane_b32 s56, v6, 0
    s_nop 1
    v_cmp_ne_u32 vcc, s56, v4
    s_nop 1
    v_cndmask_b32 v4, 0, v4, vcc
    v_mov_b32 v6, v4
    s_nop 1
    v_max_u32_dpp v6, v6, v6 row_ror:8 row_mask:0xf bank_mask:0xf
    s_nop 1
    v_max_u32_dpp v6, v6, v6 row_ror:4 row_mask:0xf bank_mask:0xf
    s_nop 1
    v_max_u32_dpp v6, v6, v6 row_ror:2 row_mask:0xf bank_mask:0xf
    s_nop 1
    v_max_u32_dpp v6, v6, v6 row_ror:1 row_mask:0xf bank_mask:0xf
    s_nop 0
    v_readlane_b32 s57, v6, 0
    s_mul_i32 s58, s29, 97
    s_cmp_eq_u32 s29, 0
    s_cselect_b32 s59, 1, 15
    s_mov_b32 s62, 0
    s_and_b32 s56, s56, 0x7ff
    s_sub_u32 s56, 2048, s56
    s_sub_i32 s56, s56, s58
    s_cmp_ge_i32 s56, s59
    s_cselect_b32 s56, s56, 0xffff
    s_cmp_lt_i32 s56, 112
    s_cselect_b32 s56, s56, 0xffff
    s_cselect_b32 s62, 1, s62
    s_and_b32 s57, s57, 0x7ff
    s_sub_u32 s57, 2048, s57
    s_sub_i32 s57, s57, s58
    s_cmp_ge_i32 s57, s59
    s_cselect_b32 s57, s57, 0xffff
    s_cmp_lt_i32 s57, 112
    s_cselect_b32 s57, s57, 0xffff
    s_cselect_b32 s62, 1, s62
    v_lshlrev_b32 v14, 2, v0
    v_add_u32 v6, 161024, v14
    s_cmp_eq_u32 s57, 0xffff
    s_cselect_b32 s58, 2147418112, 0
    v_or_b32 v15, s58, v14
    s_cmp_eq_u32 s56, 0xffff
    s_cselect_b32 s58, 2147418112, 0
    v_or_b32 v14, s58, v14
    s_mul_i32 s60, s29, 10
    s_add_u32 s60, s60, s76
    s_lshl_b32 s60, s60, 9
    s_add_u32 s60, s60, 4063232
    v_mov_b32 v8, s62
    v_mov_b32 v9, s56
    v_mov_b32 v10, s57
    v_mov_b32 v11, 1
    v_mov_b32 v7, 0
    buffer_load_dword v12, v14, s[44:47], s60 offen sc1
    buffer_load_dword v13, v15, s[44:47], s60 offen offset:256 sc1
    ds_write_b32 v6, v7 offset:512
    ds_write_b128 v30, v[8:11] offset:16
    s_waitcnt vmcnt(0) lgkmcnt(0)
    s_cmp_eq_u32 s62, 0
    s_cbranch_scc1 L_fin
    s_mov_b32 s63, 0
L_yp:
    v_max_u32 v7, v12, v13
    v_cmp_eq_u32 vcc, -1, v7
    s_add_u32 s63, s63, 1
    s_cbranch_vccz L_ypd
    s_cmp_ge_u32 s63, 40000
    s_cbranch_scc1 L_ypd
    buffer_load_dword v12, v14, s[44:47], s60 offen sc1
    buffer_load_dword v13, v15, s[44:47], s60 offen offset:256 sc1
    s_waitcnt vmcnt(0)
    s_branch L_yp
L_ypd:
    ds_write_b32 v6, v12
    ds_write_b32 v6, v13 offset:256
    ds_write_b32 v30, v11 offset:32
    s_waitcnt lgkmcnt(0)
    s_branch L_fin
L_xr_sx0:
    buffer_store_dwordx3 v[54:56], v6, s[44:47], s5 offen sc1
    s_branch L_xd_sx0
L_xr_ox0:
    buffer_store_dwordx4 v[48:51], v6, s[44:47], s15 offen sc1
    buffer_store_dwordx4 v[52:55], v6, s[44:47], s15 offen offset:1024 sc1
    s_branch L_xd_ox0
L_xr_sx1:
    buffer_store_dwordx3 v[48:50], v6, s[44:47], s4 offen sc1
    buffer_store_dwordx3 v[54:56], v6, s[44:47], s5 offen sc1
    s_branch L_xd_sx1
L_xr_ox1:
    buffer_store_dwordx4 v[48:51], v6, s[44:47], s15 offen sc1
    buffer_store_dwordx4 v[52:55], v6, s[44:47], s15 offen offset:1024 sc1
    s_branch L_xd_ox1
L_xr_sx2:
    buffer_store_dwordx3 v[48:50], v6, s[44:47], s4 offen sc1
    buffer_store_dwordx3 v[54:56], v6, s[44:47], s5 offen sc1
    s_branch L_xd_sx2
L_xr_ox2:
    buffer_store_dwordx4 v[48:51], v6, s[44:47], s15 offen sc1
    buffer_store_dwordx4 v[52:55], v6, s[44:47], s15 offen offset:1024 sc1
    s_branch L_xd_ox2
L_xr_sx3:
    buffer_store_dwordx3 v[48:50], v6, s[44:47], s4 offen sc1
    buffer_store_dwordx3 v[54:56], v6, s[44:47], s5 offen sc1
    s_branch L_xd_sx3
L_xr_ox3:
    buffer_store_dwordx4 v[48:51], v6, s[44:47], s15 offen sc1
    buffer_store_dwordx4 v[52:55], v6, s[44:47], s15 offen offset:1024 sc1
    s_branch L_xd_ox3
L_xr_sx4:
    buffer_store_dwordx3 v[48:50], v6, s[44:47], s4 offen sc1
    s_branch L_xd_sx4
L_xr_ox4:
    buffer_store_dwordx4 v[48:51], v6, s[44:47], s15 offen sc1
    buffer_store_dwordx4 v[52:55], v6, s[44:47], s15 offen offset:1024 sc1
    s_branch L_xd_ox4
L_xr_fl:
    buffer_store_dword v29, v23, s[44:47], s11 offen sc1
    s_branch L_xd_fl
L_wr_retry:
    s_add_u32 s63, s63, 1
    s_cmp_ge_u32 s63, 800000
    s_cbranch_scc1 L_wr_ok
    ds_read_b32 v24, v30 offset:40
    s_waitcnt lgkmcnt(0)
    s_branch L_wr
L_rdy_retry:
    s_add_u32 s63, s63, 1
    s_cmp_ge_u32 s63, 800000
    s_cbranch_scc1 L_rdy_ok
    ds_read_b128 v[24:27], v30 offset:16
    s_waitcnt lgkmcnt(0)
    s_branch L_rdy
L_yretry:
    s_add_u32 s63, s63, 1
    s_cmp_ge_u32 s63, 800000
    s_cbranch_scc1 L_yok
    ds_read_b32 v20, v30 offset:32
    ds_read_b128 v[48:51], v64
    ds_read_b128 v[52:55], v65
    ds_read_b128 v[56:59], v66
    ds_read_b128 v[60:63], v67
    s_branch L_yw
L_other:
    s_cmp_ge_u32 s2, 256
    s_cbranch_scc1 L_end
    s_lshr_b32 s26, s26, 6
    v_and_b32 v0, 63, v0
    s_load_dwordx4 s[20:23], s[0:1], 64
    s_load_dwordx2 s[24:25], s[0:1], 80
    s_cmp_eq_u32 s26, 0
    s_cbranch_scc0 L_other2
    s_getpc_b64 s[58:59]
L_pf_L_other:
    s_add_u32 s58, s58, L_other-L_pf_L_other
    s_addc_u32 s59, s59, -1
    v_lshlrev_b32 v255, 7, v0
    s_bfm_b64 exec, 52, 0
    global_load_dword v255, v255, s[58:59]
    s_mov_b64 exec, -1
L_other2:
    s_lshl_b32 s56, s27, 1
    s_add_u32 s56, s56, s28
    s_add_u32 s56, s56, 2
    s_cmp_eq_u32 s27, 7
    s_cselect_b32 s56, s28, s56
    s_lshl_b32 s56, s56, 3
    s_add_u32 s56, s56, s26
    s_mul_i32 s56, s56, 2
    v_lshrrev_b32 v2, 4, v0
    v_add_u32 v2, s56, v2
    v_mul_u32_u24 v3, 2185, v2
    v_lshrrev_b32 v3, 16, v3
    v_mul_u32_u24 v4, 30, v3
    v_sub_u32 v4, v2, v4
    v_mul_u32_u24 v5, 26, v4
    v_lshrrev_b32 v5, 8, v5
    v_mul_u32_u24 v5, 10, v5
    v_sub_u32 v5, v4, v5
    v_subrev_u32 v6, 10, v3
    v_mul_u32_u24 v7, 86, v6
    v_lshrrev_b32 v7, 8, v7
    v_mul_u32_u24 v8, 3, v7
    v_sub_u32 v8, v6, v8
    v_lshlrev_b32 v8, 2, v8
    v_mov_b32 v9, 0x973
    v_bfe_u32 v8, v9, v8, 4
    v_add_u32 v8, v8, v5
    v_subrev_u32 v9, 10, v8
    v_min_u32 v8, v8, v9
    v_lshl_add_u32 v8, v8, 2, v7
    v_mul_u32_u24 v9, 26, v3
    v_lshrrev_b32 v9, 8, v9
    v_mul_u32_u24 v10, 10, v9
    v_sub_u32 v10, v3, v10
    v_lshl_add_u32 v10, v10, 2, v9
    v_add_u32 v10, 3, v10
    v_cmp_gt_u32 vcc, 10, v3
    s_nop 1
    v_cndmask_b32 v8, v8, v10, vcc
    v_and_b32 v9, 15, v0
    v_lshl_add_u32 v8, v8, 4, v9
    v_mul_u32_u24 v8, 30, v8
    v_add_lshl_u32 v8, v8, v4, 7
    v_mov_b32 v9, 2147418112
    v_cmp_gt_u32 vcc, 570, v2
    s_nop 1
    v_cndmask_b32 v8, v9, v8, vcc
    s_waitcnt lgkmcnt(0)
    s_mov_b64 s[32:33], s[6:7]
    s_mov_b32 s34, 2457600
    s_mov_b32 s35, 0x00020000
    s_bfm_b64 exec, 32, 0
    buffer_load_dword v254, v8, s[32:35], 0 offen
    s_mov_b64 exec, -1
    s_cmp_eq_u32 s27, 7
    s_cbranch_scc1 L_fx
L_spare:
    s_add_u32 s56, s27, 20
    s_cmp_eq_u32 s28, 31
    s_cselect_b32 s28, s56, s28
    s_cbranch_scc1 L_ffn
    s_cmp_ge_u32 s26, 6
    s_cbranch_scc1 L_end
    s_lshr_b32 s56, s26, 1
    s_and_b32 s62, s26, 1
    s_mul_i32 s29, s27, 3
    s_add_u32 s29, s29, s56
    s_sub_u32 s29, 20, s29
    s_mov_b32 s58, 3997696
    s_lshl_b32 s60, s62, 10
    s_mul_i32 s59, s29, 40960
    s_add_u32 s59, s59, s60
    s_add_u32 s59, s59, 3014656
    s_lshl_b32 s61, s29, 11
    s_add_u32 s60, s60, s61
    s_add_u32 s60, s60, 3932160
    v_lshlrev_b32 v2, 2, v0
    v_mov_b32 v3, 0
    v_lshlrev_b32 v4, 4, v0
    s_waitcnt lgkmcnt(0)
    s_mov_b64 s[44:45], s[24:25]
    s_mov_b32 s46, 5184512
    s_mov_b32 s47, 0x00020000
    s_mov_b64 s[36:37], s[12:13]
    s_mov_b32 s38, 1280
    s_mov_b32 s39, 0x00020000
    s_mov_b64 s[52:53], s[22:23]
    s_mov_b32 s54, 256
    s_mov_b32 s55, 0x00020000
    buffer_load_dword v5, v3, s[44:47], s58 offen sc1
    buffer_load_dword v19, v4, s[44:47], s60 offen sc1
    buffer_load_dword v6, v2, s[36:39], 0 offen offset:0
    buffer_load_dword v7, v2, s[36:39], 0 offen offset:256
    buffer_load_dword v8, v2, s[36:39], 0 offen offset:512
    buffer_load_dword v9, v2, s[36:39], 0 offen offset:768
    buffer_load_dword v10, v2, s[36:39], 0 offen offset:1024
    v_add_u32 v21, 4096, v4
    v_add_u32 v22, 8192, v4
    v_add_u32 v23, 12288, v4
    v_add_u32 v24, 16384, v4
    v_add_u32 v25, 20480, v4
    v_add_u32 v26, 24576, v4
    v_add_u32 v27, 28672, v4
    v_add_u32 v28, 32768, v4
    v_add_u32 v29, 36864, v4
    v_mov_b32 v20, v4
    s_mov_b32 s57, 0x3f803f80
    v_mov_b32 v11, 0
    s_waitcnt vmcnt(0)
    v_readfirstlane_b32 s56, v5
    s_nop 0
    s_add_u32 s61, s56, 8
    s_and_b32 s56, s61, -8
    s_xor_b32 s56, s56, 0x5a3c9658
    v_dot2c_f32_bf16 v11, s57, v6
    v_dot2c_f32_bf16 v11, s57, v7
    v_dot2c_f32_bf16 v11, s57, v8
    v_dot2c_f32_bf16 v11, s57, v9
    v_dot2c_f32_bf16 v11, s57, v10
    s_nop 2
    v_add_f32_dpp v11, v11, v11 row_ror:8 row_mask:0xf bank_mask:0xf
    s_nop 1
    v_add_f32_dpp v11, v11, v11 row_ror:4 row_mask:0xf bank_mask:0xf
    s_nop 1
    v_add_f32_dpp v11, v11, v11 row_ror:2 row_mask:0xf bank_mask:0xf
    s_nop 1
    v_add_f32_dpp v11, v11, v11 row_ror:1 row_mask:0xf bank_mask:0xf
    v_mov_b32 v12, v11
    s_nop 1
    v_permlane16_swap_b32 v11, v12
    v_add_f32 v11, v11, v12
    v_mov_b32 v12, v11
    s_nop 1
    v_permlane32_swap_b32 v11, v12
    v_add_f32 v11, v11, v12
    s_mov_b32 s63, 0
L_sv:
    s_and_b32 s64, s63, 15
    s_cmp_eq_u32 s64, 15
    s_cselect_b32 s64, 2048, 0
    s_add_u32 s64, s64, s59
    buffer_load_dwordx4 v[32:35], v20, s[44:47], s64 offen sc1
    buffer_load_dwordx4 v[36:39], v21, s[44:47], s64 offen sc1
    buffer_load_dwordx4 v[40:43], v22, s[44:47], s64 offen sc1
    buffer_load_dwordx4 v[44:47], v23, s[44:47], s64 offen sc1
    buffer_load_dwordx4 v[48:51], v24, s[44:47], s64 offen sc1
    buffer_load_dwordx4 v[52:55], v25, s[44:47], s64 offen sc1
    buffer_load_dwordx4 v[56:59], v26, s[44:47], s64 offen sc1
    buffer_load_dwordx4 v[60:63], v27, s[44:47], s64 offen sc1
    buffer_load_dwordx4 v[64:67], v28, s[44:47], s64 offen sc1
    buffer_load_dwordx4 v[68:71], v29, s[44:47], s64 offen sc1
    s_add_u32 s63, s63, 1
    s_waitcnt vmcnt(0)
    v_min3_u32 v12, v35, v39, v43
    v_min3_u32 v12, v12, v47, v51
    v_min3_u32 v12, v12, v55, v59
    v_min3_u32 v12, v12, v63, v67
    v_min_u32 v12, v12, v71
    v_max3_u32 v13, v35, v39, v43
    v_max3_u32 v13, v13, v47, v51
    v_max3_u32 v13, v13, v55, v59
    v_max3_u32 v13, v13, v63, v67
    v_max_u32 v13, v13, v71
    v_xor_b32 v14, s56, v12
    v_xor_b32 v15, s56, v13
    v_or_b32 v14, v14, v15
    v_cmp_lt_u32 vcc, 7, v14
    s_cmp_ge_u32 s63, 40000
    s_cbranch_scc1 L_sv_ok
    s_cmp_eq_u64 vcc, 0
    s_cbranch_scc0 L_sv
L_sv_ok:
    v_pk_add_f32 v[32:33], v[32:33], v[36:37]
    v_add_f32 v34, v34, v38
    v_pk_add_f32 v[32:33], v[32:33], v[40:41]
    v_add_f32 v34, v34, v42
    v_pk_add_f32 v[32:33], v[32:33], v[44:45]
    v_add_f32 v34, v34, v46
    v_pk_add_f32 v[32:33], v[32:33], v[48:49]
    v_add_f32 v34, v34, v50
    v_pk_add_f32 v[32:33], v[32:33], v[52:53]
    v_add_f32 v34, v34, v54
    v_pk_add_f32 v[32:33], v[32:33], v[56:57]
    v_add_f32 v34, v34, v58
    v_pk_add_f32 v[32:33], v[32:33], v[60:61]
    v_add_f32 v34, v34, v62
    v_pk_add_f32 v[32:33], v[32:33], v[64:65]
    v_add_f32 v34, v34, v66
    v_pk_add_f32 v[32:33], v[32:33], v[68:69]
    v_add_f32 v34, v34, v70
    v_mul_f32 v32, 0x3acccccd, v32
    v_mul_f32 v33, 0x3acccccd, v33
    v_fma_f32 v18, -v32, v32, v33
    v_max_f32 v18, 0, v18
    v_cvt_pk_bf16_f32 v18, v18, v18
    v_and_b32 v18, 0xffff0000, v18
    v_add_f32 v18, 0x3727c5ac, v18
    v_cvt_pk_bf16_f32 v18, v18, v18
    v_and_b32 v18, 0xffff0000, v18
    v_sqrt_f32 v18, v18
    v_cvt_pk_bf16_f32 v16, v32, v32
    v_and_b32 v16, 0xffff0000, v16
    v_cvt_pk_bf16_f32 v17, v18, v18
    v_and_b32 v17, 0xffff0000, v17
    v_rcp_f32 v37, v17
    v_sub_f32 v36, 0, v16
    v_cmp_eq_u32 vcc, v12, v13
    v_mov_b32 v39, s56
    s_nop 0
    v_cndmask_b32 v38, 2, 1, vcc
    s_getreg_b32 s64, hwreg(HW_REG_XCC_ID, 0, 3)
    s_or_b32 s64, s64, s56
    v_cmp_ne_u32 vcc, s64, v12
    v_cmp_ne_u32 s[66:67], s64, v13
    s_nop 0
    s_or_b64 s[66:67], s[66:67], vcc
    s_cbranch_scc1 L_sf_r
    buffer_store_dwordx4 v[36:39], v4, s[44:47], s60 offen
    s_branch L_sf_d
L_sf_r:
    buffer_store_dwordx4 v[36:39], v4, s[44:47], s60 offen sc1
L_sf_d:
    v_fma_f32 v34, v36, v11, v34
    v_mul_f32 v34, v34, v37
    v_ashrrev_i32 v12, 31, v34
    v_or_b32 v12, 0x80000000, v12
    v_xor_b32 v34, v34, v12
    v_and_b32 v34, 0xfffff800, v34
    s_lshl_b32 s59, s62, 6
    v_add_u32 v12, s59, v0
    s_mul_i32 s59, s29, 97
    s_sub_u32 s59, 2048, s59
    v_sub_u32 v13, s59, v12
    v_or_b32 v34, v34, v13
    v_max_u32 v34, 1, v34
    s_cmp_eq_u32 s29, 0
    s_cselect_b32 s60, 1, 15
    s_add_u32 s59, s59, 1
    s_min_u32 s59, s59, 112
    v_cmp_le_u32 vcc, s60, v12
    s_nop 1
    v_cndmask_b32 v34, 0, v34, vcc
    v_cmp_gt_u32 vcc, s59, v12
    s_nop 1
    v_cndmask_b32 v34, 0, v34, vcc
    s_lshl_b32 s58, s26, 8
    v_add_u32 v8, s58, v2
    ds_write_b32 v8, v34
    s_waitcnt lgkmcnt(0)
    s_barrier
    s_cmp_eq_u32 s26, 0
    s_cbranch_scc0 L_fin
    ds_read_b32 v41, v2 offset:256
    ds_read_b32 v42, v2 offset:512
    ds_read_b32 v43, v2 offset:768
    ds_read_b32 v44, v2 offset:1024
    ds_read_b32 v45, v2 offset:1280
    v_mov_b32 v35, 0
    s_waitcnt lgkmcnt(4)
    v_med3_u32 v35, v34, v35, v41
    v_max_u32 v34, v34, v41
    s_waitcnt lgkmcnt(3)
    v_med3_u32 v35, v34, v35, v42
    v_max_u32 v34, v34, v42
    s_waitcnt lgkmcnt(2)
    v_med3_u32 v35, v34, v35, v43
    v_max_u32 v34, v34, v43
    s_waitcnt lgkmcnt(1)
    v_med3_u32 v35, v34, v35, v44
    v_max_u32 v34, v34, v44
    s_waitcnt lgkmcnt(0)
    v_med3_u32 v35, v34, v35, v45
    v_max_u32 v34, v34, v45
    v_mov_b32 v6, v34
    s_nop 1
    v_max_u32_dpp v6, v6, v6 row_ror:8 row_mask:0xf bank_mask:0xf
    s_nop 1
    v_max_u32_dpp v6, v6, v6 row_ror:4 row_mask:0xf bank_mask:0xf
    s_nop 1
    v_max_u32_dpp v6, v6, v6 row_ror:2 row_mask:0xf bank_mask:0xf
    s_nop 1
    v_max_u32_dpp v6, v6, v6 row_ror:1 row_mask:0xf bank_mask:0xf
    s_nop 0
    v_readlane_b32 s56, v6, 0
    v_readlane_b32 s58, v6, 16
    v_readlane_b32 s59, v6, 32
    v_readlane_b32 s60, v6, 48
    s_max_u32 s56, s56, s58
    s_max_u32 s59, s59, s60
    s_max_u32 s56, s56, s59
    v_cmp_ne_u32 vcc, s56, v34
    s_nop 1
    v_cndmask_b32 v34, v35, v34, vcc
    v_mov_b32 v6, v34
    s_nop 1
    v_max_u32_dpp v6, v6, v6 row_ror:8 row_mask:0xf bank_mask:0xf
    s_nop 1
    v_max_u32_dpp v6, v6, v6 row_ror:4 row_mask:0xf bank_mask:0xf
    s_nop 1
    v_max_u32_dpp v6, v6, v6 row_ror:2 row_mask:0xf bank_mask:0xf
    s_nop 1
    v_max_u32_dpp v6, v6, v6 row_ror:1 row_mask:0xf bank_mask:0xf
    s_nop 0
    v_readlane_b32 s57, v6, 0
    v_readlane_b32 s58, v6, 16
    v_readlane_b32 s59, v6, 32
    v_readlane_b32 s60, v6, 48
    s_max_u32 s57, s57, s58
    s_max_u32 s59, s59, s60
    s_max_u32 s57, s57, s59
    v_mov_b32 v4, s56
    v_mov_b32 v5, s57
    s_lshl_b32 s58, s27, 3
    v_mov_b32 v6, s58
    s_mov_b64 exec, 1
    buffer_store_dwordx2 v[4:5], v6, s[52:55], 0 offen sc1
    s_branch L_fin
L_fx:
    s_cmp_ge_u32 s28, 20
    s_cbranch_scc0 L_ffn

    s_sub_u32 s56, s28, 20
    s_lshl_b32 s56, s56, 3
    s_add_u32 s56, s56, s26
    s_mul_i32 s56, s56, 23040
    v_lshlrev_b32 v2, 7, v0
    v_add_u32 v3, 8192, v2
    v_add_u32 v4, 16384, v2
    s_waitcnt lgkmcnt(0)
    s_mov_b64 s[40:41], s[18:19]
    s_mov_b32 s42, 2211840
    s_mov_b32 s43, 0x00020000
    buffer_load_dword v5, v2, s[40:43], s56 offen
    buffer_load_dword v6, v3, s[40:43], s56 offen
    s_bfm_b64 exec, 52, 0
    buffer_load_dword v7, v4, s[40:43], s56 offen
    s_mov_b64 exec, -1
    s_cmp_ge_u32 s28, 30
    s_cbranch_scc1 L_fx_end
    s_cmp_ge_u32 s26, 2
    s_cbranch_scc1 L_fx_end
    s_mov_b64 s[44:45], s[24:25]
    s_mov_b32 s46, 5184512
    s_mov_b32 s47, 0x00020000
    s_mov_b64 s[52:53], s[22:23]
    s_mov_b32 s54, 256
    s_mov_b32 s55, 0x00020000
    v_lshlrev_b32 v9, 2, v0
    v_cmp_gt_u32 vcc, 14, v0
    v_mov_b32 v10, 2147418112
    s_nop 0
    v_cndmask_b32 v9, v10, v9, vcc
    s_waitcnt vmcnt(0)
    buffer_load_dword v8, v9, s[52:55], 0 offen sc1
    s_mov_b32 s58, 0
L_pk_r:
    s_waitcnt vmcnt(0)
    v_cmp_ne_u32 vcc, 0, v8
    s_add_u32 s58, s58, 1
    s_cmp_eq_u32 vcc_lo, 0x3fff
    s_cbranch_scc1 L_pkd_r
    s_cmp_ge_u32 s58, 40000
    s_cbranch_scc1 L_pkd_r
    s_sleep 32
    buffer_load_dword v8, v9, s[52:55], 0 offen sc1
    s_branch L_pk_r
L_pkd_r:
    v_mov_b32 v10, v8
    s_nop 1
    v_max_u32_dpp v10, v10, v10 row_ror:8 row_mask:0xf bank_mask:0xf
    s_nop 1
    v_max_u32_dpp v10, v10, v10 row_ror:4 row_mask:0xf bank_mask:0xf
    s_nop 1
    v_max_u32_dpp v10, v10, v10 row_ror:2 row_mask:0xf bank_mask:0xf
    s_nop 1
    v_max_u32_dpp v10, v10, v10 row_ror:1 row_mask:0xf bank_mask:0xf
    s_nop 0
    v_readlane_b32 s56, v10, 0
    s_nop 1
    v_cmp_ne_u32 vcc, s56, v8
    s_nop 1
    v_cndmask_b32 v8, 0, v8, vcc
    v_mov_b32 v10, v8
    s_nop 1
    v_max_u32_dpp v10, v10, v10 row_ror:8 row_mask:0xf bank_mask:0xf
    s_nop 1
    v_max_u32_dpp v10, v10, v10 row_ror:4 row_mask:0xf bank_mask:0xf
    s_nop 1
    v_max_u32_dpp v10, v10, v10 row_ror:2 row_mask:0xf bank_mask:0xf
    s_nop 1
    v_max_u32_dpp v10, v10, v10 row_ror:1 row_mask:0xf bank_mask:0xf
    s_nop 0
    v_readlane_b32 s57, v10, 0
    s_lshl_b32 s58, s28, 1
    s_add_u32 s58, s58, s26
    s_cmp_eq_u32 s58, 40
    s_cbranch_scc0 L_nobump
    v_mov_b32 v12, 3997696
    buffer_load_dword v13, v12, s[44:47], 0 offen sc1
    s_waitcnt vmcnt(0)
    v_add_u32 v13, 8, v13
    s_mov_b64 exec, 1
    buffer_store_dword v13, v12, s[44:47], 0 offen sc1
    s_mov_b64 exec, -1
L_nobump:
    v_mov_b32 v12, 212
    s_mov_b32 s63, 0
L_rp:
    buffer_load_dword v13, v12, s[52:55], 0 offen sc1
    s_add_u32 s63, s63, 1
    s_waitcnt vmcnt(0)
    v_readfirstlane_b32 s58, v13
    s_nop 0
    s_cmp_ge_u32 s58, 27
    s_cbranch_scc1 L_rpd
    s_sleep 16
    s_cmp_lt_u32 s63, 40000
    s_cbranch_scc1 L_rp
L_rpd:
    s_cmp_eq_u32 s26, 0
    s_cselect_b32 s56, s56, s57
    s_and_b32 s56, s56, 0x7ff
    s_sub_u32 s56, 2033, s56
    s_max_i32 s56, s56, 0
    s_mul_i32 s56, s56, 10811
    s_lshr_b32 s56, s56, 20
    s_mul_i32 s56, s56, 10
    s_sub_u32 s57, s28, 20
    s_add_u32 s56, s56, s57
    s_lshl_b32 s56, s56, 1
    s_add_u32 s56, s56, s26
    s_lshl_b32 s56, s56, 8
    s_add_u32 s56, s56, 4063232
    s_lshl_b32 s57, s57, 8
    s_mul_i32 s58, s26, 2560
    s_add_u32 s57, s57, s58
    s_add_u32 s57, s57, 5046272
    v_and_b32 v20, 15, v0
    v_lshrrev_b32 v21, 4, v0
    v_mul_u32_u24 v14, 5120, v21
    v_lshl_add_u32 v14, v20, 4, v14
    v_lshlrev_b32 v15, 4, v20
    v_lshl_add_u32 v15, v21, 2, v15
    s_add_u32 s64, s57, 0
    s_add_u32 s65, s57, 20480
    s_add_u32 s66, s57, 40960
    s_add_u32 s67, s57, 61440
    s_add_u32 s68, s57, 81920
    s_add_u32 s69, s57, 102400
    s_add_u32 s70, s57, 122880
    s_mov_b32 s63, 0
L_rg:
    buffer_load_dwordx4 v[32:35], v14, s[44:47], s64 offen sc1
    buffer_load_dwordx4 v[36:39], v14, s[44:47], s65 offen sc1
    buffer_load_dwordx4 v[40:43], v14, s[44:47], s66 offen sc1
    buffer_load_dwordx4 v[44:47], v14, s[44:47], s67 offen sc1
    buffer_load_dwordx4 v[48:51], v14, s[44:47], s68 offen sc1
    buffer_load_dwordx4 v[52:55], v14, s[44:47], s69 offen sc1
    buffer_load_dwordx4 v[56:59], v14, s[44:47], s70 offen sc1
    s_add_u32 s63, s63, 1
    v_mov_b32 v16, 0
    s_waitcnt vmcnt(6)
    v_max3_u32 v16, v16, v32, v33
    v_max3_u32 v16, v16, v34, v35
    s_waitcnt vmcnt(5)
    v_max3_u32 v16, v16, v36, v37
    v_max3_u32 v16, v16, v38, v39
    s_waitcnt vmcnt(4)
    v_max3_u32 v16, v16, v40, v41
    v_max3_u32 v16, v16, v42, v43
    s_waitcnt vmcnt(3)
    v_max3_u32 v16, v16, v44, v45
    v_max3_u32 v16, v16, v46, v47
    s_waitcnt vmcnt(2)
    v_max3_u32 v16, v16, v48, v49
    v_max3_u32 v16, v16, v50, v51
    s_waitcnt vmcnt(1)
    v_max3_u32 v16, v16, v52, v53
    v_max3_u32 v16, v16, v54, v55
    s_waitcnt vmcnt(0)
    v_max3_u32 v16, v16, v56, v57
    v_max3_u32 v16, v16, v58, v59
    v_cmp_eq_u32 vcc, -1, v16
    s_cmp_ge_u32 s63, 40000
    s_cbranch_scc1 L_rgd
    s_cbranch_vccnz L_rg
L_rgd:
    v_pk_add_f32 v[32:33], v[32:33], v[36:37]
    v_pk_add_f32 v[34:35], v[34:35], v[38:39]
    v_pk_add_f32 v[32:33], v[32:33], v[40:41]
    v_pk_add_f32 v[34:35], v[34:35], v[42:43]
    v_pk_add_f32 v[32:33], v[32:33], v[44:45]
    v_pk_add_f32 v[34:35], v[34:35], v[46:47]
    v_pk_add_f32 v[32:33], v[32:33], v[48:49]
    v_pk_add_f32 v[34:35], v[34:35], v[50:51]
    v_pk_add_f32 v[32:33], v[32:33], v[52:53]
    v_pk_add_f32 v[34:35], v[34:35], v[54:55]
    v_pk_add_f32 v[32:33], v[32:33], v[56:57]
    v_pk_add_f32 v[34:35], v[34:35], v[58:59]
    s_nop 1
    v_permlane32_swap_b32 v32, v34
    v_permlane32_swap_b32 v33, v35
    v_add_f32 v32, v32, v34
    v_add_f32 v33, v33, v35
    s_nop 1
    v_permlane16_swap_b32 v32, v33
    v_add_f32 v32, v32, v33
    buffer_store_dword v32, v15, s[44:47], s56 offen sc1
L_fx_end:
    s_waitcnt vmcnt(0)
    s_endpgm
L_ffn:

    v_lshrrev_b32 v2, 3, v0
    v_and_b32 v3, 7, v0
    v_bfe_u32 v4, v0, 4, 1
    s_and_b32 s56, s26, 1
    s_lshl_b32 s56, s56, 1
    v_or_b32 v4, s56, v4
    v_xor_b32 v4, v4, v3
    v_lshlrev_b32 v4, 4, v4
    v_mul_u32_u24 v11, 3456, v2
    v_add_u32 v10, v11, v4
    v_xor_b32 v4, 64, v4
    v_add_u32 v11, v11, v4
    s_mul_i32 s57, s26, 27648
    s_lshl_b32 s58, s28, 7
    s_add_u32 s57, s57, s58
    s_lshl_b32 s56, s26, 10
    s_mov_b32 s63, 0
    s_waitcnt lgkmcnt(0)
    s_mov_b64 s[32:33], s[14:15]
    s_mov_b32 s34, 2211840
    s_mov_b32 s35, 0x00020000
    s_mov_b64 s[36:37], s[16:17]
    s_mov_b32 s38, 2211840
    s_mov_b32 s39, 0x00020000
    s_mov_b64 s[44:45], s[24:25]
    s_mov_b32 s46, 5184512
    s_mov_b32 s47, 0x00020000
    s_cmp_eq_u32 s26, 2
    s_cbranch_scc0 L_f_ld
    v_mov_b64 v[24:25], -1
    v_mov_b64 v[26:27], -1
    v_lshlrev_b32 v28, 4, v0
    s_mul_i32 s59, s28, 5120
    s_add_u32 s59, s59, 5046272
    s_add_u32 s60, s59, 4096
    buffer_store_dwordx4 v[24:27], v28, s[44:47], s59 offen offset:0 sc1
    buffer_store_dwordx4 v[24:27], v28, s[44:47], s59 offen offset:1024 sc1
    buffer_store_dwordx4 v[24:27], v28, s[44:47], s59 offen offset:2048 sc1
    buffer_store_dwordx4 v[24:27], v28, s[44:47], s59 offen offset:3072 sc1
    buffer_store_dwordx4 v[24:27], v28, s[44:47], s60 offen offset:0 sc1
L_f_ld:
    s_mov_b32 m0, s56
    s_add_u32 s63, s63, 1
    buffer_load_dwordx4 v10, s[32:35], s57 offen nt lds
    s_add_u32 m0, s56, 40960
    s_add_u32 s56, s56, 8192
    buffer_load_dwordx4 v11, s[36:39], s57 offen nt lds
    s_add_u32 s57, s57, 221184
    s_cmp_eq_u32 s63, 5
    s_cselect_b32 s58, 40960, 0
    s_add_u32 s56, s56, s58
    s_cmp_lt_u32 s63, 10
    s_cbranch_scc1 L_f_ld
    s_mov_b64 s[40:41], s[18:19]
    s_mov_b32 s42, 2211840
    s_mov_b32 s43, 0x00020000
    s_mov_b64 s[48:49], s[4:5]
    s_mov_b32 s50, 2621440
    s_mov_b32 s51, 0x00020000
    s_mov_b64 s[52:53], s[22:23]
    s_mov_b32 s54, 256
    s_mov_b32 s55, 0x00020000
    v_lshrrev_b32 v21, 4, v0
    v_and_b32 v20, 15, v0
    v_bfe_u32 v2, v0, 2, 2
    v_lshl_add_u32 v3, v21, 3, v2
    v_bfe_u32 v5, v0, 1, 1
    v_lshrrev_b32 v6, 1, v2
    v_and_b32 v7, 1, v21
    v_lshl_or_b32 v6, v7, 1, v6
    v_lshl_or_b32 v6, v5, 2, v6
    v_xor_b32 v6, s26, v6
    v_lshlrev_b32 v6, 4, v6
    v_lshl_add_u32 v6, v3, 7, v6
    v_and_b32 v8, 1, v0
    v_lshl_add_u32 v6, v8, 3, v6
    v_mul_u32_u24 v8, 40960, v5
    v_add_u32 v12, v6, v8
    v_add_u32 v13, 81920, v12
    v_lshl_or_b32 v6, v7, 2, v2
    v_xor_b32 v6, s26, v6
    v_lshlrev_b32 v6, 5, v6
    v_lshl_add_u32 v6, v3, 8, v6
    v_and_b32 v8, 3, v0
    v_lshl_add_u32 v14, v8, 3, v6
    v_add_u32 v15, 65536, v14
    s_and_b32 s58, s26, 2
    s_lshl_b32 s58, s58, 1
    v_or_b32 v6, s58, v21
    v_lshlrev_b32 v6, 1, v6
    v_xor_b32 v6, v6, v20
    v_lshlrev_b32 v6, 4, v6
    v_mul_u32_u24 v16, 1280, v21
    v_add_u32 v16, v16, v6
    s_sub_u32 s56, s26, 4
    s_mul_i32 s57, s28, 64
    s_lshl_b32 s58, s56, 2
    s_add_u32 s57, s57, s58
    s_mul_i32 s57, s57, 1280
    s_lshl_b32 s56, s56, 10

    v_lshlrev_b32 v23, 2, v0
    v_cmp_gt_u32 vcc, 14, v0
    v_mov_b32 v6, 2147418112
    s_nop 0
    v_cndmask_b32 v23, v6, v23, vcc
    s_cmp_eq_u32 s26, 2
    s_cbranch_scc0 L_f_w1
    v_mov_b32 v4, 1
    v_mov_b32 v9, 212
    s_waitcnt vmcnt(0)
    s_mov_b64 exec, 1
    buffer_atomic_add v4, v9, s[52:55], 0 offen sc1
    s_mov_b64 exec, -1
L_f_w1:
    s_waitcnt vmcnt(10)
L_f_b1:
    s_barrier
    ds_read_b64_tr_b16 v[40:41], v12 offset:0
    ds_read_b64_tr_b16 v[42:43], v12 offset:512
    ds_read_b64_tr_b16 v[44:45], v12 offset:4096
    ds_read_b64_tr_b16 v[46:47], v12 offset:4608
    ds_read_b64_tr_b16 v[48:49], v12 offset:8192
    ds_read_b64_tr_b16 v[50:51], v12 offset:8704
    ds_read_b64_tr_b16 v[52:53], v12 offset:12288
    ds_read_b64_tr_b16 v[54:55], v12 offset:12800
    ds_read_b64_tr_b16 v[56:57], v12 offset:16384
    ds_read_b64_tr_b16 v[58:59], v12 offset:16896
    ds_read_b64_tr_b16 v[60:61], v12 offset:20480
    ds_read_b64_tr_b16 v[62:63], v12 offset:20992
    s_waitcnt lgkmcnt(4)
    ds_read_b64_tr_b16 v[64:65], v12 offset:24576
    ds_read_b64_tr_b16 v[66:67], v12 offset:25088
    ds_read_b64_tr_b16 v[68:69], v12 offset:28672
    ds_read_b64_tr_b16 v[70:71], v12 offset:29184
    ds_read_b64_tr_b16 v[72:73], v12 offset:32768
    ds_read_b64_tr_b16 v[74:75], v12 offset:33280
    ds_read_b64_tr_b16 v[76:77], v12 offset:36864
    ds_read_b64_tr_b16 v[78:79], v12 offset:37376
    s_waitcnt lgkmcnt(0)
    s_barrier
    s_cmp_ge_u32 s26, 4
    s_cbranch_scc0 L_f_nod
    s_mov_b32 s63, 0
L_f_wda:
    s_add_u32 m0, s56, 0
    s_nop 0
    buffer_load_dwordx4 v16, s[40:43], s57 offen lds
    s_add_u32 m0, s56, 16128
    s_nop 0
    buffer_load_dwordx4 v16, s[40:43], s57 offen offset:256 lds
    s_add_u32 m0, s56, 32256
    s_nop 0
    buffer_load_dwordx4 v16, s[40:43], s57 offen offset:512 lds
    s_add_u32 m0, s56, 48384
    s_nop 0
    buffer_load_dwordx4 v16, s[40:43], s57 offen offset:768 lds
    s_add_u32 m0, s56, 64512
    s_nop 0
    buffer_load_dwordx4 v16, s[40:43], s57 offen offset:1024 lds
    s_add_u32 s57, s57, 20480
    s_add_u32 s56, s56, 4096
    s_add_u32 s63, s63, 1
    s_cmp_lt_u32 s63, 2
    s_cbranch_scc1 L_f_wda
    s_waitcnt vmcnt(10)
    s_branch L_f_d
L_f_nod:
    s_cmp_ge_u32 s26, 2
    s_cbranch_scc1 L_f_w3
    buffer_load_dword v4, v23, s[52:55], 0 offen sc1
    s_waitcnt vmcnt(1)
    s_branch L_f_d
L_f_w3:
    s_waitcnt vmcnt(0)
L_f_d:
    s_barrier
    ds_read_b64_tr_b16 v[80:81], v13 offset:0
    ds_read_b64_tr_b16 v[82:83], v13 offset:512
    ds_read_b64_tr_b16 v[84:85], v13 offset:4096
    ds_read_b64_tr_b16 v[86:87], v13 offset:4608
    ds_read_b64_tr_b16 v[88:89], v13 offset:8192
    ds_read_b64_tr_b16 v[90:91], v13 offset:8704
    ds_read_b64_tr_b16 v[92:93], v13 offset:12288
    ds_read_b64_tr_b16 v[94:95], v13 offset:12800
    ds_read_b64_tr_b16 v[96:97], v13 offset:16384
    ds_read_b64_tr_b16 v[98:99], v13 offset:16896
    ds_read_b64_tr_b16 v[100:101], v13 offset:20480
    ds_read_b64_tr_b16 v[102:103], v13 offset:20992
    s_waitcnt lgkmcnt(4)
    ds_read_b64_tr_b16 v[104:105], v13 offset:24576
    ds_read_b64_tr_b16 v[106:107], v13 offset:25088
    ds_read_b64_tr_b16 v[108:109], v13 offset:28672
    ds_read_b64_tr_b16 v[110:111], v13 offset:29184
    ds_read_b64_tr_b16 v[112:113], v13 offset:32768
    ds_read_b64_tr_b16 v[114:115], v13 offset:33280
    ds_read_b64_tr_b16 v[116:117], v13 offset:36864
    ds_read_b64_tr_b16 v[118:119], v13 offset:37376
    s_waitcnt lgkmcnt(0)
    s_barrier
    s_cmp_ge_u32 s26, 4
    s_cbranch_scc0 L_f_nod2
    s_mov_b32 s63, 0
L_f_wdb:
    s_add_u32 m0, s56, 0
    s_nop 0
    buffer_load_dwordx4 v16, s[40:43], s57 offen lds
    s_add_u32 m0, s56, 16128
    s_nop 0
    buffer_load_dwordx4 v16, s[40:43], s57 offen offset:256 lds
    s_add_u32 m0, s56, 32256
    s_nop 0
    buffer_load_dwordx4 v16, s[40:43], s57 offen offset:512 lds
    s_add_u32 m0, s56, 48384
    s_nop 0
    buffer_load_dwordx4 v16, s[40:43], s57 offen offset:768 lds
    s_add_u32 m0, s56, 64512
    s_nop 0
    buffer_load_dwordx4 v16, s[40:43], s57 offen offset:1024 lds
    s_add_u32 s57, s57, 20480
    s_add_u32 s56, s56, 4096
    s_add_u32 s63, s63, 1
    s_cmp_lt_u32 s63, 2
    s_cbranch_scc1 L_f_wdb
    s_branch L_f_x
L_f_nod2:
    s_cmp_ge_u32 s26, 2
    s_cbranch_scc1 L_f_x
    s_setprio 3
    s_mov_b32 s58, 0
L_pk_f:
    s_waitcnt vmcnt(0)
    v_cmp_ne_u32 vcc, 0, v4
    s_add_u32 s58, s58, 1
    s_cmp_eq_u32 vcc_lo, 0x3fff
    s_cbranch_scc1 L_pkd_f
    s_cmp_ge_u32 s58, 40000
    s_cbranch_scc1 L_pkd_f

    buffer_load_dword v4, v23, s[52:55], 0 offen sc1
    s_branch L_pk_f
L_pkd_f:
    v_mov_b32 v6, v4
    s_nop 1
    v_max_u32_dpp v6, v6, v6 row_ror:8 row_mask:0xf bank_mask:0xf
    s_nop 1
    v_max_u32_dpp v6, v6, v6 row_ror:4 row_mask:0xf bank_mask:0xf
    s_nop 1
    v_max_u32_dpp v6, v6, v6 row_ror:2 row_mask:0xf bank_mask:0xf
    s_nop 1
    v_max_u32_dpp v6, v6, v6 row_ror:1 row_mask:0xf bank_mask:0xf
    s_nop 0
    v_readlane_b32 s56, v6, 0
    s_nop 1
    v_cmp_ne_u32 vcc, s56, v4
    s_nop 1
    v_cndmask_b32 v4, 0, v4, vcc
    v_mov_b32 v6, v4
    s_nop 1
    v_max_u32_dpp v6, v6, v6 row_ror:8 row_mask:0xf bank_mask:0xf
    s_nop 1
    v_max_u32_dpp v6, v6, v6 row_ror:4 row_mask:0xf bank_mask:0xf
    s_nop 1
    v_max_u32_dpp v6, v6, v6 row_ror:2 row_mask:0xf bank_mask:0xf
    s_nop 1
    v_max_u32_dpp v6, v6, v6 row_ror:1 row_mask:0xf bank_mask:0xf
    s_nop 0
    v_readlane_b32 s57, v6, 0
    s_cmp_eq_u32 s26, 0
    s_cselect_b32 s56, s56, s57
    s_and_b32 s57, s56, 0x7ff
    s_sub_u32 s57, 2047, s57
    s_mul_i32 s57, s57, 1280
    v_lshlrev_b32 v5, 2, v0
    buffer_load_dword v24, v5, s[48:51], s57 offen offset:0
    buffer_load_dword v25, v5, s[48:51], s57 offen offset:256
    buffer_load_dword v26, v5, s[48:51], s57 offen offset:512
    buffer_load_dword v27, v5, s[48:51], s57 offen offset:768
    buffer_load_dword v28, v5, s[48:51], s57 offen offset:1024
    s_and_b32 s56, s56, 0xfffff800
    s_or_b32 s56, s56, 0x400
    s_ashr_i32 s58, s56, 31
    s_not_b32 s58, s58
    s_or_b32 s58, s58, 0x80000000
    s_xor_b32 s56, s56, s58
    v_mov_b32 v6, s56
    v_cvt_pk_bf16_f32 v6, v6, v6
    v_and_b32 v6, 0xffff0000, v6
    v_mul_f32 v6, 0xbfb8aa3b, v6
    v_exp_f32 v6, v6
    s_nop 0
    v_add_f32 v6, 1.0, v6
    v_rcp_f32 v6, v6
    s_nop 0
    v_cvt_pk_bf16_f32 v6, v6, v6
    v_and_b32 v6, 0xffff0000, v6
    s_lshl_b32 s58, s26, 2
    s_add_u32 s58, s58, 86528
    v_mov_b32 v7, s58
    s_mov_b32 s59, 0x3f803f80
    v_mov_b32 v9, 0
    v_mov_b32 v10, 0
    s_waitcnt vmcnt(0)
    v_dot2c_f32_bf16 v9, s59, v24
    v_dot2c_f32_bf16 v10, v24, v24
    v_dot2c_f32_bf16 v9, s59, v25
    v_dot2c_f32_bf16 v10, v25, v25
    v_dot2c_f32_bf16 v9, s59, v26
    v_dot2c_f32_bf16 v10, v26, v26
    v_dot2c_f32_bf16 v9, s59, v27
    v_dot2c_f32_bf16 v10, v27, v27
    v_dot2c_f32_bf16 v9, s59, v28
    v_dot2c_f32_bf16 v10, v28, v28
    s_nop 1
    v_add_f32_dpp v9, v9, v9 row_ror:8 row_mask:0xf bank_mask:0xf
    v_add_f32_dpp v10, v10, v10 row_ror:8 row_mask:0xf bank_mask:0xf
    s_nop 0
    v_add_f32_dpp v9, v9, v9 row_ror:4 row_mask:0xf bank_mask:0xf
    v_add_f32_dpp v10, v10, v10 row_ror:4 row_mask:0xf bank_mask:0xf
    s_nop 0
    v_add_f32_dpp v9, v9, v9 row_ror:2 row_mask:0xf bank_mask:0xf
    v_add_f32_dpp v10, v10, v10 row_ror:2 row_mask:0xf bank_mask:0xf
    s_nop 0
    v_add_f32_dpp v9, v9, v9 row_ror:1 row_mask:0xf bank_mask:0xf
    v_add_f32_dpp v10, v10, v10 row_ror:1 row_mask:0xf bank_mask:0xf
    s_nop 1
    v_permlane32_swap_b32 v9, v10
    v_add_f32 v9, v9, v10
    v_mov_b32 v10, v9
    s_nop 1
    v_permlane16_swap_b32 v9, v10
    v_add_f32 v9, v9, v10
    v_mov_b32 v10, v9
    s_nop 1
    v_permlane32_swap_b32 v9, v10
    v_mul_f32 v9, 0x3acccccd, v9
    v_mul_f32 v10, 0x3acccccd, v10
    v_fma_f32 v19, -v9, v9, v10
    v_max_f32 v19, 0, v19
    v_cvt_pk_bf16_f32 v19, v19, v19
    v_and_b32 v19, 0xffff0000, v19
    v_add_f32 v19, 0x3727c5ac, v19
    v_cvt_pk_bf16_f32 v19, v19, v19
    v_and_b32 v19, 0xffff0000, v19
    v_sqrt_f32 v19, v19
    v_cvt_pk_bf16_f32 v17, v9, v9
    v_and_b32 v17, 0xffff0000, v17
    v_cvt_pk_bf16_f32 v18, v19, v19
    v_and_b32 v18, 0xffff0000, v18
    v_rcp_f32 v18, v18
    s_mul_i32 s58, s26, 1344
    s_add_u32 s58, s58, 81920
    v_add_u32 v5, s58, v5
    v_lshlrev_b32 v30, 16, v24
    v_and_b32 v31, 0xffff0000, v24
    v_sub_f32 v30, v30, v17
    v_sub_f32 v31, v31, v17
    v_cvt_pk_bf16_f32 v31, v30, v31
    v_lshlrev_b32 v30, 16, v31
    v_and_b32 v31, 0xffff0000, v31
    v_mul_f32 v30, v30, v18
    v_mul_f32 v31, v31, v18
    v_cvt_pk_bf16_f32 v32, v30, v31
    v_lshlrev_b32 v30, 16, v25
    v_and_b32 v31, 0xffff0000, v25
    v_sub_f32 v30, v30, v17
    v_sub_f32 v31, v31, v17
    v_cvt_pk_bf16_f32 v31, v30, v31
    v_lshlrev_b32 v30, 16, v31
    v_and_b32 v31, 0xffff0000, v31
    v_mul_f32 v30, v30, v18
    v_mul_f32 v31, v31, v18
    v_cvt_pk_bf16_f32 v33, v30, v31
    v_lshlrev_b32 v30, 16, v26
    v_and_b32 v31, 0xffff0000, v26
    v_sub_f32 v30, v30, v17
    v_sub_f32 v31, v31, v17
    v_cvt_pk_bf16_f32 v31, v30, v31
    v_lshlrev_b32 v30, 16, v31
    v_and_b32 v31, 0xffff0000, v31
    v_mul_f32 v30, v30, v18
    v_mul_f32 v31, v31, v18
    v_cvt_pk_bf16_f32 v34, v30, v31
    v_lshlrev_b32 v30, 16, v27
    v_and_b32 v31, 0xffff0000, v27
    v_sub_f32 v30, v30, v17
    v_sub_f32 v31, v31, v17
    v_cvt_pk_bf16_f32 v31, v30, v31
    v_lshlrev_b32 v30, 16, v31
    v_and_b32 v31, 0xffff0000, v31
    v_mul_f32 v30, v30, v18
    v_mul_f32 v31, v31, v18
    v_cvt_pk_bf16_f32 v35, v30, v31
    v_lshlrev_b32 v30, 16, v28
    v_and_b32 v31, 0xffff0000, v28
    v_sub_f32 v30, v30, v17
    v_sub_f32 v31, v31, v17
    v_cvt_pk_bf16_f32 v31, v30, v31
    v_lshlrev_b32 v30, 16, v31
    v_and_b32 v31, 0xffff0000, v31
    v_mul_f32 v30, v30, v18
    v_mul_f32 v31, v31, v18
    v_cvt_pk_bf16_f32 v36, v30, v31
    ds_write_b32 v7, v6
    ds_write_b32 v5, v32 offset:0
    ds_write_b32 v5, v33 offset:256
    ds_write_b32 v5, v34 offset:512
    ds_write_b32 v5, v35 offset:768
    ds_write_b32 v5, v36 offset:1024
L_f_x:
    v_and_b32 v2, 1, v0
    v_mul_u32_u24 v3, 1344, v2
    v_lshl_add_u32 v3, v21, 4, v3
    v_add_u32 v3, 81920, v3
    v_lshlrev_b32 v8, 7, v2
    v_lshl_add_u32 v8, v21, 4, v8
    v_add_u32 v8, 86016, v8
    v_lshlrev_b32 v5, 2, v2
    v_add_u32 v5, 86528, v5
    s_waitcnt lgkmcnt(0)
    s_barrier
    ds_read_b128 v[120:123], v3 offset:0
    ds_read_b128 v[124:127], v3 offset:64
    ds_read_b128 v[128:131], v3 offset:128
    ds_read_b128 v[132:135], v3 offset:192
    ds_read_b128 v[136:139], v3 offset:256
    ds_read_b128 v[140:143], v3 offset:320
    ds_read_b128 v[144:147], v3 offset:384
    ds_read_b128 v[148:151], v3 offset:448
    ds_read_b128 v[152:155], v3 offset:512
    s_waitcnt lgkmcnt(8)
    v_mfma_f32_16x16x32_bf16 v[24:27], v[40:43], v[120:123], 0
    ds_read_b128 v[156:159], v3 offset:576
    s_waitcnt lgkmcnt(8)
    v_mfma_f32_16x16x32_bf16 v[28:31], v[44:47], v[124:127], 0
    ds_read_b128 v[160:163], v3 offset:640
    s_waitcnt lgkmcnt(8)
    v_mfma_f32_16x16x32_bf16 v[24:27], v[48:51], v[128:131], v[24:27]
    ds_read_b128 v[164:167], v3 offset:704
    s_waitcnt lgkmcnt(8)
    v_mfma_f32_16x16x32_bf16 v[28:31], v[52:55], v[132:135], v[28:31]
    ds_read_b128 v[168:171], v3 offset:768
    s_waitcnt lgkmcnt(8)
    v_mfma_f32_16x16x32_bf16 v[24:27], v[56:59], v[136:139], v[24:27]
    ds_read_b128 v[172:175], v3 offset:832
    s_waitcnt lgkmcnt(8)
    v_mfma_f32_16x16x32_bf16 v[28:31], v[60:63], v[140:143], v[28:31]
    ds_read_b128 v[176:179], v3 offset:896
    s_waitcnt lgkmcnt(8)
    v_mfma_f32_16x16x32_bf16 v[24:27], v[64:67], v[144:147], v[24:27]
    ds_read_b128 v[180:183], v3 offset:960
    s_waitcnt lgkmcnt(8)
    v_mfma_f32_16x16x32_bf16 v[28:31], v[68:71], v[148:151], v[28:31]
    ds_read_b128 v[184:187], v3 offset:1024
    s_waitcnt lgkmcnt(8)
    v_mfma_f32_16x16x32_bf16 v[24:27], v[72:75], v[152:155], v[24:27]
    ds_read_b128 v[188:191], v3 offset:1088
    s_waitcnt lgkmcnt(8)
    v_mfma_f32_16x16x32_bf16 v[28:31], v[76:79], v[156:159], v[28:31]
    ds_read_b128 v[192:195], v3 offset:1152
    s_waitcnt lgkmcnt(8)
    v_mfma_f32_16x16x32_bf16 v[24:27], v[80:83], v[160:163], v[24:27]
    ds_read_b128 v[196:199], v3 offset:1216
    s_waitcnt lgkmcnt(8)
    v_mfma_f32_16x16x32_bf16 v[28:31], v[84:87], v[164:167], v[28:31]
    s_waitcnt lgkmcnt(7)
    v_mfma_f32_16x16x32_bf16 v[24:27], v[88:91], v[168:171], v[24:27]
    s_waitcnt lgkmcnt(6)
    v_mfma_f32_16x16x32_bf16 v[28:31], v[92:95], v[172:175], v[28:31]
    s_waitcnt lgkmcnt(5)
    v_mfma_f32_16x16x32_bf16 v[24:27], v[96:99], v[176:179], v[24:27]
    s_waitcnt lgkmcnt(4)
    v_mfma_f32_16x16x32_bf16 v[28:31], v[100:103], v[180:183], v[28:31]
    s_waitcnt lgkmcnt(3)
    v_mfma_f32_16x16x32_bf16 v[24:27], v[104:107], v[184:187], v[24:27]
    s_waitcnt lgkmcnt(2)
    v_mfma_f32_16x16x32_bf16 v[28:31], v[108:111], v[188:191], v[28:31]
    s_waitcnt lgkmcnt(1)
    v_mfma_f32_16x16x32_bf16 v[24:27], v[112:115], v[192:195], v[24:27]
    s_waitcnt lgkmcnt(0)
    v_mfma_f32_16x16x32_bf16 v[28:31], v[116:119], v[196:199], v[28:31]
    ds_read_b32 v22, v5
    s_mov_b32 s60, 0xcccccccc
    s_mov_b32 s61, 0xcccccccc
    s_mov_b32 s62, 0xf0f0f0f0
    s_mov_b32 s63, 0xf0f0f0f0
    v_lshlrev_b32 v6, 7, v2
    v_and_b32 v7, 1, v21
    v_lshl_add_u32 v6, v7, 3, v6
    v_and_b32 v7, 6, v0
    v_add_u32 v6, v6, v7
    s_lshl_b32 s58, s26, 4
    s_add_u32 s58, s58, 86016
    v_add_u32 v6, s58, v6
    v_pk_add_f32 v[24:25], v[24:25], v[28:29]
    v_pk_add_f32 v[26:27], v[26:27], v[30:31]
    v_cndmask_b32 v24, v24, v25, s[60:61]
    v_cndmask_b32 v26, v26, v27, s[60:61]
    v_cndmask_b32 v24, v24, v26, s[62:63]
    v_cvt_pk_bf16_f32 v24, v24, v24
    v_and_b32 v24, 0xffff0000, v24
    v_mov_b32 v28, v24
    s_nop 1
    v_permlane32_swap_b32 v24, v28
    v_mul_f32 v32, 0xbfb8aa3b, v24
    v_exp_f32 v32, v32
    s_nop 0
    v_add_f32 v32, 1.0, v32
    v_rcp_f32 v32, v32
    s_nop 0
    v_mul_f32 v24, v24, v32
    v_cvt_pk_bf16_f32 v24, v24, v24
    v_and_b32 v24, 0xffff0000, v24
    v_mul_f32 v24, v24, v28
    v_cvt_pk_bf16_f32 v24, v24, v24
    ds_write_b16 v6, v24
    s_waitcnt vmcnt(0) lgkmcnt(0)
    s_barrier
    ds_read_b128 v[24:27], v8
    ds_read_b128 v[28:31], v8 offset:64
    ds_read_b64_tr_b16 v[40:41], v14 offset:0
    ds_read_b64_tr_b16 v[42:43], v14 offset:1024
    ds_read_b64_tr_b16 v[44:45], v14 offset:8192
    ds_read_b64_tr_b16 v[46:47], v14 offset:9216
    ds_read_b64_tr_b16 v[48:49], v14 offset:16384
    ds_read_b64_tr_b16 v[50:51], v14 offset:17408
    ds_read_b64_tr_b16 v[52:53], v14 offset:24576
    ds_read_b64_tr_b16 v[54:55], v14 offset:25600
    ds_read_b64_tr_b16 v[56:57], v14 offset:32768
    ds_read_b64_tr_b16 v[58:59], v14 offset:33792
    ds_read_b64_tr_b16 v[60:61], v14 offset:40960
    ds_read_b64_tr_b16 v[62:63], v14 offset:41984
    s_waitcnt lgkmcnt(4)
    ds_read_b64_tr_b16 v[64:65], v14 offset:49152
    ds_read_b64_tr_b16 v[66:67], v14 offset:50176
    ds_read_b64_tr_b16 v[68:69], v14 offset:57344
    ds_read_b64_tr_b16 v[70:71], v14 offset:58368
    ds_read_b64_tr_b16 v[72:73], v15 offset:0
    ds_read_b64_tr_b16 v[74:75], v15 offset:1024
    ds_read_b64_tr_b16 v[76:77], v15 offset:8192
    ds_read_b64_tr_b16 v[78:79], v15 offset:9216
    v_mul_u32_u24 v6, 2560, v20
    v_lshl_add_u32 v6, v21, 4, v6
    v_mov_b32 v7, 2147418112
    v_cmp_gt_u32 vcc, 2, v20
    s_nop 1
    v_cndmask_b32 v6, v7, v6, vcc
    s_mul_i32 s58, s28, 5120
    s_lshl_b32 s59, s26, 6
    s_add_u32 s58, s58, s59
    s_add_u32 s58, s58, 5046272
    s_waitcnt lgkmcnt(0)
    v_mfma_f32_16x16x32_bf16 v[120:123], v[40:43], v[24:27], 0
    v_mfma_f32_16x16x32_bf16 v[124:127], v[48:51], v[24:27], 0
    v_mfma_f32_16x16x32_bf16 v[128:131], v[56:59], v[24:27], 0
    v_mfma_f32_16x16x32_bf16 v[132:135], v[64:67], v[24:27], 0
    v_mfma_f32_16x16x32_bf16 v[136:139], v[72:75], v[24:27], 0
    v_mfma_f32_16x16x32_bf16 v[120:123], v[44:47], v[28:31], v[120:123]
    v_mfma_f32_16x16x32_bf16 v[124:127], v[52:55], v[28:31], v[124:127]
    v_mfma_f32_16x16x32_bf16 v[128:131], v[60:63], v[28:31], v[128:131]
    v_mfma_f32_16x16x32_bf16 v[132:135], v[68:71], v[28:31], v[132:135]
    v_mfma_f32_16x16x32_bf16 v[136:139], v[76:79], v[28:31], v[136:139]
    s_nop 3
    v_mul_f32 v120, v120, v22
    v_mul_f32 v121, v121, v22
    v_mul_f32 v122, v122, v22
    v_mul_f32 v123, v123, v22
    buffer_store_dwordx4 v[120:123], v6, s[44:47], s58 offen offset:0 sc1
    v_mul_f32 v124, v124, v22
    v_mul_f32 v125, v125, v22
    v_mul_f32 v126, v126, v22
    v_mul_f32 v127, v127, v22
    buffer_store_dwordx4 v[124:127], v6, s[44:47], s58 offen offset:512 sc1
    v_mul_f32 v128, v128, v22
    v_mul_f32 v129, v129, v22
    v_mul_f32 v130, v130, v22
    v_mul_f32 v131, v131, v22
    buffer_store_dwordx4 v[128:131], v6, s[44:47], s58 offen offset:1024 sc1
    v_mul_f32 v132, v132, v22
    v_mul_f32 v133, v133, v22
    v_mul_f32 v134, v134, v22
    v_mul_f32 v135, v135, v22
    buffer_store_dwordx4 v[132:135], v6, s[44:47], s58 offen offset:1536 sc1
    v_mul_f32 v136, v136, v22
    v_mul_f32 v137, v137, v22
    v_mul_f32 v138, v138, v22
    v_mul_f32 v139, v139, v22
    buffer_store_dwordx4 v[136:139], v6, s[44:47], s58 offen offset:2048 sc1
L_fin:
L_end:
    s_endpgm
L_code_end:
.if L_code_end - L_other < 6656
.fill (6656 - (L_code_end - L_other)) / 4, 4, 0xbf810000
.endif
.section .rodata,"a"
.p2align 6
.amdhsa_kernel parallel_sum__sliding_local_dilated__moe_arch_mod__prompt_kernel
  .amdhsa_next_free_vgpr 256
  .amdhsa_next_free_sgpr 102
  .amdhsa_accum_offset 256
  .amdhsa_group_segment_fixed_size 0
  .amdhsa_kernarg_size 88
  .amdhsa_user_sgpr_count 2
  .amdhsa_user_sgpr_kernarg_segment_ptr 1
  .amdhsa_system_sgpr_workgroup_id_x 1
  .amdhsa_float_denorm_mode_32 3
.end_amdhsa_kernel
```
